```python
import torch

def _softmax(x, axis=-1):
    return torch.softmax(x, dim=axis)
def _gelu(x):
    return torch.nn.functional.gelu(x, approximate="tanh")
def _silu(x):
    return torch.nn.functional.silu(x)
def _sigmoid(x):
    return torch.sigmoid(x)
def _layernorm(x, axis=-1, eps=1e-5):
    m = x.mean(dim=axis, keepdim=True)
    v = x.var(dim=axis, keepdim=True, unbiased=False)
    return (x - m) / torch.sqrt(v + eps)
def _scatter_add(tgt, idx, src, axis=0):
    return tgt.clone().index_add_(axis, idx, src)
def _segment_sum(src, seg, n):
    out = torch.zeros((n,) + src.shape[1:], dtype=src.dtype)
    return out.index_add_(0, seg, src)
def _pad(x, pw):
    flat = tuple(v for pair in reversed(pw) for v in pair)
    return torch.nn.functional.pad(x, flat)

kernel_name = 'recurrent_scan__mha_block_cached__geglu_ffn__decode'

def setup_inputs():

    _w = (lambda a: (lambda t: t.to(torch.bfloat16) if t.is_floating_point() else t)(torch.as_tensor(a)))
    def _A_setup():
        B, Sq, D = 2, 1, 512
        H, Sk, Dh = 32, 16384, 128
        return {
            "x": _w((lambda *s: torch.randn(*s, dtype=torch.bfloat16) * 0.05)(B, Sq, D)),
            "k_cache": _w((lambda *s: torch.randn(*s, dtype=torch.bfloat16) * 1.6)(B, H, Sk, Dh)),
            "v_cache": _w((lambda *s: torch.randn(*s, dtype=torch.bfloat16) * 0.2)(B, H, Sk, Dh)),
            "wq": _w((lambda *s: torch.randn(*s, dtype=torch.bfloat16) * 1.6)(D, H * Dh) * (D ** -0.5)),
            "wo": _w((lambda *s: torch.randn(*s, dtype=torch.bfloat16) * 0.2)(H * Dh, D) * ((H * Dh) ** -0.5)),
        }
    _A_in = _A_setup()

    def _B_setup():
        B, S, D, F = 2, 1, 512, 1376
        return {
            "x": _w((lambda *s: torch.randn(*s, dtype=torch.bfloat16) * 0.05)(B, S, D)),
            "w_gate": _w((lambda *s: torch.randn(*s, dtype=torch.bfloat16) * 0.1)(D, F)),
            "w_up": _w((lambda *s: torch.randn(*s, dtype=torch.bfloat16) * 0.1)(D, F)),
            "w_down": _w((lambda *s: torch.randn(*s, dtype=torch.bfloat16) * 0.1)(F, D)),
        }
    _B_in = _B_setup()

    return {
        "A_x": _A_in["x"],
        "A_k_cache": _A_in["k_cache"],
        "A_v_cache": _A_in["v_cache"],
        "A_wq": _A_in["wq"],
        "A_wo": _A_in["wo"],
        "B_x": _B_in["x"],
        "B_w_gate": _B_in["w_gate"],
        "B_w_up": _B_in["w_up"],
        "B_w_down": _B_in["w_down"],
    }

def reference(A_x, A_k_cache, A_v_cache, A_wq, A_wo, B_x, B_w_gate, B_w_up, B_w_down):
    def _A_ref(x, k_cache, v_cache, wq, wo):
        B, Sq, D = x.shape
        H, Dh = 32, 128
        q = (lambda x, *d: x.permute(*d))((x @ wq).reshape(B, Sq, H, Dh), 0, 2, 1, 3)
        scores = torch.einsum("bhqd,bhkd->bhqk", q, k_cache) * (Dh ** -0.5)
        p = _softmax(scores, axis=-1)
        o = torch.einsum("bhqk,bhkd->bhqd", p, v_cache)
        return (lambda x, *d: x.permute(*d))(o, 0, 2, 1, 3).reshape(B, Sq, H * Dh) @ wo

    def _B_ref(x, w_gate, w_up, w_down):
        return (_gelu(x @ w_gate) * (x @ w_up)) @ w_down

    x = A_x
    xn = _layernorm(x, axis=-1)
    s = _A_ref(xn, A_k_cache, A_v_cache, A_wq, A_wo)
    g = _silu(_B_ref(xn, B_w_gate, B_w_up, B_w_down))
    return x + s * g
```

```asm
; @launch kernel=attn_kernel grid=(256,1,1) block=(1024,1,1) lds=77824
; @launch kernel=proj_kernel grid=(171,1,1) block=(256,1,1) lds=40960
.amdgcn_target "amdgcn-amd-amdhsa--gfx950"
.text
.globl attn_kernel
.p2align 8
.type attn_kernel,@function
attn_kernel:
  s_cmp_ge_u32 s2, 256
  s_cbranch_scc1 A_end
  s_load_dwordx8 s[4:11], s[0:1], 0
  s_load_dwordx2 s[12:13], s[0:1], 88
  s_load_dwordx4 s[52:55], s[0:1], 48
  s_load_dwordx2 s[70:71], s[0:1], 32
  s_load_dwordx2 s[72:73], s[0:1], 64
  v_and_b32 v1, 63, v0
  v_lshrrev_b32 v26, 6, v0
  s_and_b32 s74, s2, 7
  s_lshr_b32 s75, s2, 3
  s_and_b32 s37, s75, 3
  s_lshl_b32 s37, s37, 3
  s_add_u32 s74, s74, s37
  s_lshr_b32 s75, s75, 2
  s_lshr_b32 s37, s75, 2
  s_lshl_b32 s37, s37, 5
  s_add_u32 s37, s37, s74
  s_and_b32 s75, s75, 3
  s_lshl_b32 s74, s37, 2
  s_add_u32 s74, s74, s75
  s_lshr_b32 s37, s74, 2
  s_lshr_b32 s38, s37, 5
  s_and_b32 s39, s37, 31
  s_lshl_b32 s36, s74, 20
  s_lshl_b32 s40, s38, 10
  s_lshl_b32 s41, s39, 8
  v_lshlrev_b32 v27, 4, v1
  v_lshl_add_u32 v2, v26, 13, v27
  v_add_u32 v3, 4096, v2
  v_lshrrev_b32 v28, 4, v0
  v_and_b32 v29, 15, v0
  v_lshlrev_b32 v29, 4, v29
  v_lshl_add_u32 v28, v28, 13, v29
  s_waitcnt lgkmcnt(0)
  s_mov_b32 s16, s6
  s_and_b32 s17, s7, 0xffff
  s_mov_b32 s18, 268435456
  s_mov_b32 s19, 0x00020000
  s_mov_b32 s20, s8
  s_and_b32 s21, s9, 0xffff
  s_mov_b32 s22, 268435456
  s_mov_b32 s23, 0x00020000
  s_mov_b32 s24, s10
  s_and_b32 s25, s11, 0xffff
  s_mov_b32 s26, 4194304
  s_mov_b32 s27, 0x00020000
  s_mov_b32 s28, s4
  s_and_b32 s29, s5, 0xffff
  s_mov_b32 s30, 2048
  s_mov_b32 s31, 0x00020000
  s_mov_b32 s32, s12
  s_and_b32 s33, s13, 0xffff
  s_mov_b32 s34, 1073741824
  s_mov_b32 s35, 0x00020000
  s_cmp_lt_u32 s2, 176
  s_cselect_b32 s51, 1409024, 0
  s_mov_b32 s56, s52
  s_and_b32 s57, s53, 0xffff
  s_mov_b32 s58, s51
  s_mov_b32 s59, 0x00020000
  s_mov_b32 s60, s54
  s_and_b32 s61, s55, 0xffff
  s_mov_b32 s62, s51
  s_mov_b32 s63, 0x00020000
  s_and_b32 s65, s2, 7
  s_lshr_b32 s66, s2, 3
  s_mul_i32 s49, s65, 176128
  s_lshl_b32 s50, s66, 7
  s_add_u32 s49, s49, s50
  v_and_b32 v29, 511, v0
  v_lshrrev_b32 v29, 3, v29
  s_movk_i32 s48, 2752
  v_mul_lo_u32 v29, v29, s48
  v_and_b32 v30, 7, v0
  v_lshl_add_u32 v29, v30, 4, v29
  v_readfirstlane_b32 s64, v26
  buffer_load_dwordx4 v[16:19], v27, s[28:31], 0 offen
  buffer_load_dwordx4 v[4:7], v27, s[28:31], 0 offen offset:1024
  buffer_load_dwordx4 v[96:99], v28, s[24:27], s41 offen nt
  s_add_u32 s41, s41, 0x80000
  buffer_load_dwordx4 v[100:103], v28, s[24:27], s41 offen nt
  s_add_u32 s41, s41, 0x80000
  buffer_load_dwordx4 v[104:107], v28, s[24:27], s41 offen nt
  s_add_u32 s41, s41, 0x80000
  buffer_load_dwordx4 v[108:111], v28, s[24:27], s41 offen nt
  s_add_u32 s41, s41, 0x80000
  buffer_load_dwordx4 v[112:115], v28, s[24:27], s41 offen nt
  s_add_u32 s41, s41, 0x80000
  buffer_load_dwordx4 v[116:119], v28, s[24:27], s41 offen nt
  s_add_u32 s41, s41, 0x80000
  buffer_load_dwordx4 v[120:123], v28, s[24:27], s41 offen nt
  s_add_u32 s41, s41, 0x80000
  buffer_load_dwordx4 v[124:127], v28, s[24:27], s41 offen nt
  s_cmp_ge_u32 s64, 8
  s_cbranch_scc1 A_ldu
  buffer_load_dwordx4 v[92:95], v29, s[56:59], s49 offen nt
  s_branch A_ldd
A_ldu:
  buffer_load_dwordx4 v[92:95], v29, s[60:63], s49 offen nt
A_ldd:
  buffer_load_dwordx4 v[32:35], v2, s[16:19], s36 offen offset:0 nt
  buffer_load_dwordx4 v[36:39], v2, s[16:19], s36 offen offset:1024 nt
  buffer_load_dwordx4 v[40:43], v2, s[16:19], s36 offen offset:2048 nt
  buffer_load_dwordx4 v[44:47], v2, s[16:19], s36 offen offset:3072 nt
  buffer_load_dwordx4 v[48:51], v3, s[16:19], s36 offen offset:0 nt
  buffer_load_dwordx4 v[52:55], v3, s[16:19], s36 offen offset:1024 nt
  buffer_load_dwordx4 v[56:59], v3, s[16:19], s36 offen offset:2048 nt
  buffer_load_dwordx4 v[60:63], v3, s[16:19], s36 offen offset:3072 nt
  s_add_u32 s36, s36, 131072
  buffer_load_dwordx4 v[64:67], v2, s[16:19], s36 offen offset:0 nt
  buffer_load_dwordx4 v[68:71], v2, s[16:19], s36 offen offset:1024 nt
  buffer_load_dwordx4 v[72:75], v2, s[16:19], s36 offen offset:2048 nt
  buffer_load_dwordx4 v[76:79], v2, s[16:19], s36 offen offset:3072 nt
  buffer_load_dwordx4 v[80:83], v3, s[16:19], s36 offen offset:0 nt
  buffer_load_dwordx4 v[84:87], v3, s[16:19], s36 offen offset:1024 nt
  buffer_load_dwordx4 v[88:91], v3, s[16:19], s36 offen offset:2048 nt
  s_cmp_lg_u32 s2, 0
  s_cbranch_scc1 A_nozero
  v_cmp_gt_u32 vcc, 512, v0
  s_and_saveexec_b64 s[42:43], vcc
  s_cbranch_execz A_zrest
  v_mov_b32 v20, 0
  v_mov_b32 v21, 0
  v_mov_b32 v22, 0
  v_mov_b32 v23, 0
  v_lshlrev_b32 v24, 4, v0
  v_add_u32 v24, 262144, v24
  buffer_store_dwordx4 v[20:23], v24, s[32:35], 0 offen
A_zrest:
  s_mov_b64 exec, s[42:43]
  s_nop 1
A_nozero:
  s_waitcnt vmcnt(24)
  v_lshlrev_b32 v8, 16, v16
  v_and_b32 v9, 0xffff0000, v16
  v_lshlrev_b32 v10, 16, v17
  v_and_b32 v11, 0xffff0000, v17
  v_lshlrev_b32 v12, 16, v18
  v_and_b32 v13, 0xffff0000, v18
  v_lshlrev_b32 v14, 16, v19
  v_and_b32 v15, 0xffff0000, v19
  v_add_f32 v20, v8, v9
  v_add_f32 v20, v20, v10
  v_add_f32 v20, v20, v11
  v_add_f32 v20, v20, v12
  v_add_f32 v20, v20, v13
  v_add_f32 v20, v20, v14
  v_add_f32 v20, v20, v15
  s_nop 1
  v_add_f32_dpp v20, v20, v20 row_ror:8 row_mask:0xf bank_mask:0xf
  s_nop 1
  v_add_f32_dpp v20, v20, v20 row_ror:4 row_mask:0xf bank_mask:0xf
  s_nop 1
  v_add_f32_dpp v20, v20, v20 row_ror:2 row_mask:0xf bank_mask:0xf
  s_nop 1
  v_add_f32_dpp v20, v20, v20 row_ror:1 row_mask:0xf bank_mask:0xf
  s_nop 1
  v_readlane_b32 s44, v20, 0
  v_readlane_b32 s45, v20, 16
  v_readlane_b32 s46, v20, 32
  v_readlane_b32 s47, v20, 48
  s_nop 1
  v_mov_b32 v20, s44
  v_add_f32 v20, s45, v20
  v_add_f32 v20, s46, v20
  v_add_f32 v20, s47, v20
  v_mul_f32 v20, 0x3b000000, v20
  v_sub_f32 v22, v8, v20
  v_mul_f32 v21, v22, v22
  v_sub_f32 v22, v9, v20
  v_fmac_f32 v21, v22, v22
  v_sub_f32 v22, v10, v20
  v_fmac_f32 v21, v22, v22
  v_sub_f32 v22, v11, v20
  v_fmac_f32 v21, v22, v22
  v_sub_f32 v22, v12, v20
  v_fmac_f32 v21, v22, v22
  v_sub_f32 v22, v13, v20
  v_fmac_f32 v21, v22, v22
  v_sub_f32 v22, v14, v20
  v_fmac_f32 v21, v22, v22
  v_sub_f32 v22, v15, v20
  v_fmac_f32 v21, v22, v22
  s_nop 1
  v_add_f32_dpp v21, v21, v21 row_ror:8 row_mask:0xf bank_mask:0xf
  s_nop 1
  v_add_f32_dpp v21, v21, v21 row_ror:4 row_mask:0xf bank_mask:0xf
  s_nop 1
  v_add_f32_dpp v21, v21, v21 row_ror:2 row_mask:0xf bank_mask:0xf
  s_nop 1
  v_add_f32_dpp v21, v21, v21 row_ror:1 row_mask:0xf bank_mask:0xf
  s_nop 1
  v_readlane_b32 s44, v21, 0
  v_readlane_b32 s45, v21, 16
  v_readlane_b32 s46, v21, 32
  v_readlane_b32 s47, v21, 48
  s_nop 1
  v_mov_b32 v21, s44
  v_add_f32 v21, s45, v21
  v_add_f32 v21, s46, v21
  v_add_f32 v21, s47, v21
  v_mul_f32 v21, 0x3b000000, v21
  v_cvt_pk_bf16_f32 v20, v20, v20
  v_lshlrev_b32 v20, 16, v20
  v_cvt_pk_bf16_f32 v21, v21, v21
  v_lshlrev_b32 v21, 16, v21
  v_add_f32 v21, 0x3727c5ac, v21
  v_cvt_pk_bf16_f32 v21, v21, v21
  v_lshlrev_b32 v21, 16, v21
  v_sqrt_f32 v21, v21
  s_nop 0
  v_cvt_pk_bf16_f32 v21, v21, v21
  v_lshlrev_b32 v21, 16, v21
  v_rcp_f32 v22, v21
  s_nop 0
  v_sub_f32 v23, v8, v20
  v_cvt_pk_bf16_f32 v23, v23, v23
  v_lshlrev_b32 v23, 16, v23
  v_mul_f32 v24, v23, v22
  v_fma_f32 v25, -v24, v21, v23
  v_fma_f32 v24, v25, v22, v24
  v_cvt_pk_bf16_f32 v8, v24, v24
  v_lshlrev_b32 v8, 16, v8
  v_sub_f32 v23, v9, v20
  v_cvt_pk_bf16_f32 v23, v23, v23
  v_lshlrev_b32 v23, 16, v23
  v_mul_f32 v24, v23, v22
  v_fma_f32 v25, -v24, v21, v23
  v_fma_f32 v24, v25, v22, v24
  v_cvt_pk_bf16_f32 v9, v24, v24
  v_lshlrev_b32 v9, 16, v9
  v_sub_f32 v23, v10, v20
  v_cvt_pk_bf16_f32 v23, v23, v23
  v_lshlrev_b32 v23, 16, v23
  v_mul_f32 v24, v23, v22
  v_fma_f32 v25, -v24, v21, v23
  v_fma_f32 v24, v25, v22, v24
  v_cvt_pk_bf16_f32 v10, v24, v24
  v_lshlrev_b32 v10, 16, v10
  v_sub_f32 v23, v11, v20
  v_cvt_pk_bf16_f32 v23, v23, v23
  v_lshlrev_b32 v23, 16, v23
  v_mul_f32 v24, v23, v22
  v_fma_f32 v25, -v24, v21, v23
  v_fma_f32 v24, v25, v22, v24
  v_cvt_pk_bf16_f32 v11, v24, v24
  v_lshlrev_b32 v11, 16, v11
  v_sub_f32 v23, v12, v20
  v_cvt_pk_bf16_f32 v23, v23, v23
  v_lshlrev_b32 v23, 16, v23
  v_mul_f32 v24, v23, v22
  v_fma_f32 v25, -v24, v21, v23
  v_fma_f32 v24, v25, v22, v24
  v_cvt_pk_bf16_f32 v12, v24, v24
  v_lshlrev_b32 v12, 16, v12
  v_sub_f32 v23, v13, v20
  v_cvt_pk_bf16_f32 v23, v23, v23
  v_lshlrev_b32 v23, 16, v23
  v_mul_f32 v24, v23, v22
  v_fma_f32 v25, -v24, v21, v23
  v_fma_f32 v24, v25, v22, v24
  v_cvt_pk_bf16_f32 v13, v24, v24
  v_lshlrev_b32 v13, 16, v13
  v_sub_f32 v23, v14, v20
  v_cvt_pk_bf16_f32 v23, v23, v23
  v_lshlrev_b32 v23, 16, v23
  v_mul_f32 v24, v23, v22
  v_fma_f32 v25, -v24, v21, v23
  v_fma_f32 v24, v25, v22, v24
  v_cvt_pk_bf16_f32 v14, v24, v24
  v_lshlrev_b32 v14, 16, v14
  v_sub_f32 v23, v15, v20
  v_cvt_pk_bf16_f32 v23, v23, v23
  v_lshlrev_b32 v23, 16, v23
  v_mul_f32 v24, v23, v22
  v_fma_f32 v25, -v24, v21, v23
  v_fma_f32 v24, v25, v22, v24
  v_cvt_pk_bf16_f32 v15, v24, v24
  v_lshlrev_b32 v15, 16, v15
  v_lshlrev_b32 v30, 5, v1
  ds_write_b128 v30, v[8:11] offset:37888
  ds_write_b128 v30, v[12:15] offset:37904
  v_lshlrev_b32 v8, 16, v4
  v_and_b32 v9, 0xffff0000, v4
  v_lshlrev_b32 v10, 16, v5
  v_and_b32 v11, 0xffff0000, v5
  v_lshlrev_b32 v12, 16, v6
  v_and_b32 v13, 0xffff0000, v6
  v_lshlrev_b32 v14, 16, v7
  v_and_b32 v15, 0xffff0000, v7
  v_add_f32 v20, v8, v9
  v_add_f32 v20, v20, v10
  v_add_f32 v20, v20, v11
  v_add_f32 v20, v20, v12
  v_add_f32 v20, v20, v13
  v_add_f32 v20, v20, v14
  v_add_f32 v20, v20, v15
  s_nop 1
  v_add_f32_dpp v20, v20, v20 row_ror:8 row_mask:0xf bank_mask:0xf
  s_nop 1
  v_add_f32_dpp v20, v20, v20 row_ror:4 row_mask:0xf bank_mask:0xf
  s_nop 1
  v_add_f32_dpp v20, v20, v20 row_ror:2 row_mask:0xf bank_mask:0xf
  s_nop 1
  v_add_f32_dpp v20, v20, v20 row_ror:1 row_mask:0xf bank_mask:0xf
  s_nop 1
  v_readlane_b32 s44, v20, 0
  v_readlane_b32 s45, v20, 16
  v_readlane_b32 s46, v20, 32
  v_readlane_b32 s47, v20, 48
  s_nop 1
  v_mov_b32 v20, s44
  v_add_f32 v20, s45, v20
  v_add_f32 v20, s46, v20
  v_add_f32 v20, s47, v20
  v_mul_f32 v20, 0x3b000000, v20
  v_sub_f32 v22, v8, v20
  v_mul_f32 v21, v22, v22
  v_sub_f32 v22, v9, v20
  v_fmac_f32 v21, v22, v22
  v_sub_f32 v22, v10, v20
  v_fmac_f32 v21, v22, v22
  v_sub_f32 v22, v11, v20
  v_fmac_f32 v21, v22, v22
  v_sub_f32 v22, v12, v20
  v_fmac_f32 v21, v22, v22
  v_sub_f32 v22, v13, v20
  v_fmac_f32 v21, v22, v22
  v_sub_f32 v22, v14, v20
  v_fmac_f32 v21, v22, v22
  v_sub_f32 v22, v15, v20
  v_fmac_f32 v21, v22, v22
  s_nop 1
  v_add_f32_dpp v21, v21, v21 row_ror:8 row_mask:0xf bank_mask:0xf
  s_nop 1
  v_add_f32_dpp v21, v21, v21 row_ror:4 row_mask:0xf bank_mask:0xf
  s_nop 1
  v_add_f32_dpp v21, v21, v21 row_ror:2 row_mask:0xf bank_mask:0xf
  s_nop 1
  v_add_f32_dpp v21, v21, v21 row_ror:1 row_mask:0xf bank_mask:0xf
  s_nop 1
  v_readlane_b32 s44, v21, 0
  v_readlane_b32 s45, v21, 16
  v_readlane_b32 s46, v21, 32
  v_readlane_b32 s47, v21, 48
  s_nop 1
  v_mov_b32 v21, s44
  v_add_f32 v21, s45, v21
  v_add_f32 v21, s46, v21
  v_add_f32 v21, s47, v21
  v_mul_f32 v21, 0x3b000000, v21
  v_cvt_pk_bf16_f32 v20, v20, v20
  v_lshlrev_b32 v20, 16, v20
  v_cvt_pk_bf16_f32 v21, v21, v21
  v_lshlrev_b32 v21, 16, v21
  v_add_f32 v21, 0x3727c5ac, v21
  v_cvt_pk_bf16_f32 v21, v21, v21
  v_lshlrev_b32 v21, 16, v21
  v_sqrt_f32 v21, v21
  s_nop 0
  v_cvt_pk_bf16_f32 v21, v21, v21
  v_lshlrev_b32 v21, 16, v21
  v_rcp_f32 v22, v21
  s_nop 0
  v_sub_f32 v23, v8, v20
  v_cvt_pk_bf16_f32 v23, v23, v23
  v_lshlrev_b32 v23, 16, v23
  v_mul_f32 v24, v23, v22
  v_fma_f32 v25, -v24, v21, v23
  v_fma_f32 v24, v25, v22, v24
  v_cvt_pk_bf16_f32 v8, v24, v24
  v_lshlrev_b32 v8, 16, v8
  v_sub_f32 v23, v9, v20
  v_cvt_pk_bf16_f32 v23, v23, v23
  v_lshlrev_b32 v23, 16, v23
  v_mul_f32 v24, v23, v22
  v_fma_f32 v25, -v24, v21, v23
  v_fma_f32 v24, v25, v22, v24
  v_cvt_pk_bf16_f32 v9, v24, v24
  v_lshlrev_b32 v9, 16, v9
  v_sub_f32 v23, v10, v20
  v_cvt_pk_bf16_f32 v23, v23, v23
  v_lshlrev_b32 v23, 16, v23
  v_mul_f32 v24, v23, v22
  v_fma_f32 v25, -v24, v21, v23
  v_fma_f32 v24, v25, v22, v24
  v_cvt_pk_bf16_f32 v10, v24, v24
  v_lshlrev_b32 v10, 16, v10
  v_sub_f32 v23, v11, v20
  v_cvt_pk_bf16_f32 v23, v23, v23
  v_lshlrev_b32 v23, 16, v23
  v_mul_f32 v24, v23, v22
  v_fma_f32 v25, -v24, v21, v23
  v_fma_f32 v24, v25, v22, v24
  v_cvt_pk_bf16_f32 v11, v24, v24
  v_lshlrev_b32 v11, 16, v11
  v_sub_f32 v23, v12, v20
  v_cvt_pk_bf16_f32 v23, v23, v23
  v_lshlrev_b32 v23, 16, v23
  v_mul_f32 v24, v23, v22
  v_fma_f32 v25, -v24, v21, v23
  v_fma_f32 v24, v25, v22, v24
  v_cvt_pk_bf16_f32 v12, v24, v24
  v_lshlrev_b32 v12, 16, v12
  v_sub_f32 v23, v13, v20
  v_cvt_pk_bf16_f32 v23, v23, v23
  v_lshlrev_b32 v23, 16, v23
  v_mul_f32 v24, v23, v22
  v_fma_f32 v25, -v24, v21, v23
  v_fma_f32 v24, v25, v22, v24
  v_cvt_pk_bf16_f32 v13, v24, v24
  v_lshlrev_b32 v13, 16, v13
  v_sub_f32 v23, v14, v20
  v_cvt_pk_bf16_f32 v23, v23, v23
  v_lshlrev_b32 v23, 16, v23
  v_mul_f32 v24, v23, v22
  v_fma_f32 v25, -v24, v21, v23
  v_fma_f32 v24, v25, v22, v24
  v_cvt_pk_bf16_f32 v14, v24, v24
  v_lshlrev_b32 v14, 16, v14
  v_sub_f32 v23, v15, v20
  v_cvt_pk_bf16_f32 v23, v23, v23
  v_lshlrev_b32 v23, 16, v23
  v_mul_f32 v24, v23, v22
  v_fma_f32 v25, -v24, v21, v23
  v_fma_f32 v24, v25, v22, v24
  v_cvt_pk_bf16_f32 v15, v24, v24
  v_lshlrev_b32 v15, 16, v15
  ds_write_b128 v30, v[8:11] offset:39936
  ds_write_b128 v30, v[12:15] offset:39952
  v_lshrrev_b32 v31, 4, v0
  v_lshlrev_b32 v31, 2, v31
  s_lshl_b32 s40, s38, 11
  v_add_u32 v31, s40, v31
  v_and_b32 v30, 511, v0
  v_lshrrev_b32 v30, 3, v30
  s_lshl_b32 s40, s65, 8
  v_lshl_add_u32 v30, v30, 2, s40
  s_waitcnt lgkmcnt(0)
  ds_read_b32 v16, v31 offset:37888
  ds_read_b32 v17, v31 offset:38144
  ds_read_b32 v18, v31 offset:38400
  ds_read_b32 v19, v31 offset:38656
  ds_read_b32 v20, v31 offset:38912
  ds_read_b32 v21, v31 offset:39168
  ds_read_b32 v22, v31 offset:39424
  ds_read_b32 v23, v31 offset:39680
  ds_read_b32 v27, v30 offset:37888
  ds_read_b32 v28, v30 offset:39936
  v_mov_b32 v8, 0
  v_mov_b32 v9, 0
  v_mov_b32 v10, 0
  v_mov_b32 v11, 0
  v_mov_b32 v12, 0
  v_mov_b32 v13, 0
  v_mov_b32 v14, 0
  v_mov_b32 v15, 0
  s_waitcnt vmcnt(16) lgkmcnt(0)
  v_lshlrev_b32 v24, 16, v96
  v_and_b32 v25, 0xffff0000, v96
  v_fmac_f32 v8, v24, v16
  v_fmac_f32 v9, v25, v16
  v_lshlrev_b32 v24, 16, v97
  v_and_b32 v25, 0xffff0000, v97
  v_fmac_f32 v10, v24, v16
  v_fmac_f32 v11, v25, v16
  v_lshlrev_b32 v24, 16, v98
  v_and_b32 v25, 0xffff0000, v98
  v_fmac_f32 v12, v24, v16
  v_fmac_f32 v13, v25, v16
  v_lshlrev_b32 v24, 16, v99
  v_and_b32 v25, 0xffff0000, v99
  v_fmac_f32 v14, v24, v16
  v_fmac_f32 v15, v25, v16
  v_lshlrev_b32 v24, 16, v100
  v_and_b32 v25, 0xffff0000, v100
  v_fmac_f32 v8, v24, v17
  v_fmac_f32 v9, v25, v17
  v_lshlrev_b32 v24, 16, v101
  v_and_b32 v25, 0xffff0000, v101
  v_fmac_f32 v10, v24, v17
  v_fmac_f32 v11, v25, v17
  v_lshlrev_b32 v24, 16, v102
  v_and_b32 v25, 0xffff0000, v102
  v_fmac_f32 v12, v24, v17
  v_fmac_f32 v13, v25, v17
  v_lshlrev_b32 v24, 16, v103
  v_and_b32 v25, 0xffff0000, v103
  v_fmac_f32 v14, v24, v17
  v_fmac_f32 v15, v25, v17
  v_lshlrev_b32 v24, 16, v104
  v_and_b32 v25, 0xffff0000, v104
  v_fmac_f32 v8, v24, v18
  v_fmac_f32 v9, v25, v18
  v_lshlrev_b32 v24, 16, v105
  v_and_b32 v25, 0xffff0000, v105
  v_fmac_f32 v10, v24, v18
  v_fmac_f32 v11, v25, v18
  v_lshlrev_b32 v24, 16, v106
  v_and_b32 v25, 0xffff0000, v106
  v_fmac_f32 v12, v24, v18
  v_fmac_f32 v13, v25, v18
  v_lshlrev_b32 v24, 16, v107
  v_and_b32 v25, 0xffff0000, v107
  v_fmac_f32 v14, v24, v18
  v_fmac_f32 v15, v25, v18
  v_lshlrev_b32 v24, 16, v108
  v_and_b32 v25, 0xffff0000, v108
  v_fmac_f32 v8, v24, v19
  v_fmac_f32 v9, v25, v19
  v_lshlrev_b32 v24, 16, v109
  v_and_b32 v25, 0xffff0000, v109
  v_fmac_f32 v10, v24, v19
  v_fmac_f32 v11, v25, v19
  v_lshlrev_b32 v24, 16, v110
  v_and_b32 v25, 0xffff0000, v110
  v_fmac_f32 v12, v24, v19
  v_fmac_f32 v13, v25, v19
  v_lshlrev_b32 v24, 16, v111
  v_and_b32 v25, 0xffff0000, v111
  v_fmac_f32 v14, v24, v19
  v_fmac_f32 v15, v25, v19
  v_lshlrev_b32 v24, 16, v112
  v_and_b32 v25, 0xffff0000, v112
  v_fmac_f32 v8, v24, v20
  v_fmac_f32 v9, v25, v20
  v_lshlrev_b32 v24, 16, v113
  v_and_b32 v25, 0xffff0000, v113
  v_fmac_f32 v10, v24, v20
  v_fmac_f32 v11, v25, v20
  v_lshlrev_b32 v24, 16, v114
  v_and_b32 v25, 0xffff0000, v114
  v_fmac_f32 v12, v24, v20
  v_fmac_f32 v13, v25, v20
  v_lshlrev_b32 v24, 16, v115
  v_and_b32 v25, 0xffff0000, v115
  v_fmac_f32 v14, v24, v20
  v_fmac_f32 v15, v25, v20
  v_lshlrev_b32 v24, 16, v116
  v_and_b32 v25, 0xffff0000, v116
  v_fmac_f32 v8, v24, v21
  v_fmac_f32 v9, v25, v21
  v_lshlrev_b32 v24, 16, v117
  v_and_b32 v25, 0xffff0000, v117
  v_fmac_f32 v10, v24, v21
  v_fmac_f32 v11, v25, v21
  v_lshlrev_b32 v24, 16, v118
  v_and_b32 v25, 0xffff0000, v118
  v_fmac_f32 v12, v24, v21
  v_fmac_f32 v13, v25, v21
  v_lshlrev_b32 v24, 16, v119
  v_and_b32 v25, 0xffff0000, v119
  v_fmac_f32 v14, v24, v21
  v_fmac_f32 v15, v25, v21
  v_lshlrev_b32 v24, 16, v120
  v_and_b32 v25, 0xffff0000, v120
  v_fmac_f32 v8, v24, v22
  v_fmac_f32 v9, v25, v22
  v_lshlrev_b32 v24, 16, v121
  v_and_b32 v25, 0xffff0000, v121
  v_fmac_f32 v10, v24, v22
  v_fmac_f32 v11, v25, v22
  v_lshlrev_b32 v24, 16, v122
  v_and_b32 v25, 0xffff0000, v122
  v_fmac_f32 v12, v24, v22
  v_fmac_f32 v13, v25, v22
  v_lshlrev_b32 v24, 16, v123
  v_and_b32 v25, 0xffff0000, v123
  v_fmac_f32 v14, v24, v22
  v_fmac_f32 v15, v25, v22
  v_lshlrev_b32 v24, 16, v124
  v_and_b32 v25, 0xffff0000, v124
  v_fmac_f32 v8, v24, v23
  v_fmac_f32 v9, v25, v23
  v_lshlrev_b32 v24, 16, v125
  v_and_b32 v25, 0xffff0000, v125
  v_fmac_f32 v10, v24, v23
  v_fmac_f32 v11, v25, v23
  v_lshlrev_b32 v24, 16, v126
  v_and_b32 v25, 0xffff0000, v126
  v_fmac_f32 v12, v24, v23
  v_fmac_f32 v13, v25, v23
  v_lshlrev_b32 v24, 16, v127
  v_and_b32 v25, 0xffff0000, v127
  v_fmac_f32 v14, v24, v23
  v_fmac_f32 v15, v25, v23
  v_lshlrev_b32 v30, 5, v0
  ds_write_b128 v30, v[8:11] offset:0
  ds_write_b128 v30, v[12:15] offset:16
  s_waitcnt vmcnt(15)
  v_lshlrev_b32 v112, 16, v92
  v_and_b32 v113, 0xffff0000, v92
  v_lshlrev_b32 v114, 16, v93
  v_and_b32 v115, 0xffff0000, v93
  v_lshlrev_b32 v116, 16, v94
  v_and_b32 v117, 0xffff0000, v94
  v_lshlrev_b32 v118, 16, v95
  v_and_b32 v119, 0xffff0000, v95
  v_mul_f32 v96, v112, v27
  v_mul_f32 v104, v112, v28
  v_mul_f32 v97, v113, v27
  v_mul_f32 v105, v113, v28
  v_mul_f32 v98, v114, v27
  v_mul_f32 v106, v114, v28
  v_mul_f32 v99, v115, v27
  v_mul_f32 v107, v115, v28
  v_mul_f32 v100, v116, v27
  v_mul_f32 v108, v116, v28
  v_mul_f32 v101, v117, v27
  v_mul_f32 v109, v117, v28
  v_mul_f32 v102, v118, v27
  v_mul_f32 v110, v118, v28
  v_mul_f32 v103, v119, v27
  v_mul_f32 v111, v119, v28
  buffer_load_dwordx4 v[92:95], v3, s[16:19], s36 offen offset:3072 nt
  s_sub_u32 s36, s36, 131072
  v_add_f32_dpp v96, v96, v96 row_ror:8 row_mask:0xf bank_mask:0xf
  v_add_f32_dpp v97, v97, v97 row_ror:8 row_mask:0xf bank_mask:0xf
  v_add_f32_dpp v98, v98, v98 row_ror:8 row_mask:0xf bank_mask:0xf
  v_add_f32_dpp v99, v99, v99 row_ror:8 row_mask:0xf bank_mask:0xf
  v_add_f32_dpp v100, v100, v100 row_ror:8 row_mask:0xf bank_mask:0xf
  v_add_f32_dpp v101, v101, v101 row_ror:8 row_mask:0xf bank_mask:0xf
  v_add_f32_dpp v102, v102, v102 row_ror:8 row_mask:0xf bank_mask:0xf
  v_add_f32_dpp v103, v103, v103 row_ror:8 row_mask:0xf bank_mask:0xf
  v_add_f32_dpp v104, v104, v104 row_ror:8 row_mask:0xf bank_mask:0xf
  v_add_f32_dpp v105, v105, v105 row_ror:8 row_mask:0xf bank_mask:0xf
  v_add_f32_dpp v106, v106, v106 row_ror:8 row_mask:0xf bank_mask:0xf
  v_add_f32_dpp v107, v107, v107 row_ror:8 row_mask:0xf bank_mask:0xf
  v_add_f32_dpp v108, v108, v108 row_ror:8 row_mask:0xf bank_mask:0xf
  v_add_f32_dpp v109, v109, v109 row_ror:8 row_mask:0xf bank_mask:0xf
  v_add_f32_dpp v110, v110, v110 row_ror:8 row_mask:0xf bank_mask:0xf
  v_add_f32_dpp v111, v111, v111 row_ror:8 row_mask:0xf bank_mask:0xf
  v_lshrrev_b32 v24, 4, v0
  v_lshlrev_b32 v24, 9, v24
  v_and_b32 v25, 7, v0
  v_lshl_add_u32 v24, v25, 5, v24
  ds_write_b128 v24, v[96:99] offset:43008
  ds_write_b128 v24, v[100:103] offset:43024
  ds_write_b128 v24, v[104:107] offset:43264
  ds_write_b128 v24, v[108:111] offset:43280
  v_and_b32 v24, 127, v0
  v_lshrrev_b32 v25, 7, v0
  v_lshlrev_b32 v24, 2, v24
  v_lshl_add_u32 v31, v25, 12, v24
  s_waitcnt lgkmcnt(0)
  s_barrier
  ds_read_b32 v16, v31 offset:0
  ds_read_b32 v17, v31 offset:512
  ds_read_b32 v18, v31 offset:1024
  ds_read_b32 v19, v31 offset:1536
  ds_read_b32 v20, v31 offset:2048
  ds_read_b32 v21, v31 offset:2560
  ds_read_b32 v22, v31 offset:3072
  ds_read_b32 v23, v31 offset:3584
  v_lshlrev_b32 v29, 2, v0
  s_waitcnt lgkmcnt(0)
  v_add_f32 v16, v16, v17
  v_add_f32 v16, v16, v18
  v_add_f32 v16, v16, v19
  v_add_f32 v16, v16, v20
  v_add_f32 v16, v16, v21
  v_add_f32 v16, v16, v22
  v_add_f32 v16, v16, v23
  ds_write_b32 v29, v16 offset:32768
  s_cmp_ge_u32 s64, 4
  s_cbranch_scc1 A_nf1
  s_cmp_ge_u32 s2, 176
  s_cbranch_scc1 A_nf1
  v_lshrrev_b32 v24, 7, v0
  v_and_b32 v25, 127, v0
  v_lshlrev_b32 v24, 14, v24
  v_lshl_add_u32 v24, v25, 2, v24
  ds_read_b32 v96, v24 offset:43008
  ds_read_b32 v97, v24 offset:43520
  ds_read_b32 v98, v24 offset:44032
  ds_read_b32 v99, v24 offset:44544
  ds_read_b32 v100, v24 offset:45056
  ds_read_b32 v101, v24 offset:45568
  ds_read_b32 v102, v24 offset:46080
  ds_read_b32 v103, v24 offset:46592
  ds_read_b32 v104, v24 offset:47104
  ds_read_b32 v105, v24 offset:47616
  ds_read_b32 v106, v24 offset:48128
  ds_read_b32 v107, v24 offset:48640
  ds_read_b32 v108, v24 offset:49152
  ds_read_b32 v109, v24 offset:49664
  ds_read_b32 v110, v24 offset:50176
  ds_read_b32 v111, v24 offset:50688
  ds_read_b32 v112, v24 offset:51200
  ds_read_b32 v113, v24 offset:51712
  ds_read_b32 v114, v24 offset:52224
  ds_read_b32 v115, v24 offset:52736
  ds_read_b32 v116, v24 offset:53248
  ds_read_b32 v117, v24 offset:53760
  ds_read_b32 v118, v24 offset:54272
  ds_read_b32 v119, v24 offset:54784
  ds_read_b32 v120, v24 offset:55296
  ds_read_b32 v121, v24 offset:55808
  ds_read_b32 v122, v24 offset:56320
  ds_read_b32 v123, v24 offset:56832
  ds_read_b32 v124, v24 offset:57344
  ds_read_b32 v125, v24 offset:57856
  ds_read_b32 v126, v24 offset:58368
  ds_read_b32 v127, v24 offset:58880
  s_lshl_b32 s48, s65, 2
  s_add_u32 s48, s48, s64
  s_mul_i32 s48, s48, 5632
  s_lshl_b32 s49, s66, 8
  s_add_u32 s48, s48, s49
  s_add_u32 s48, s48, 270336
  v_lshlrev_b32 v25, 2, v1
  s_waitcnt lgkmcnt(0)
  v_add_f32 v96, v96, v97
  v_add_f32 v96, v96, v98
  v_add_f32 v96, v96, v99
  v_add_f32 v96, v96, v100
  v_add_f32 v96, v96, v101
  v_add_f32 v96, v96, v102
  v_add_f32 v96, v96, v103
  v_add_f32 v96, v96, v104
  v_add_f32 v96, v96, v105
  v_add_f32 v96, v96, v106
  v_add_f32 v96, v96, v107
  v_add_f32 v96, v96, v108
  v_add_f32 v96, v96, v109
  v_add_f32 v96, v96, v110
  v_add_f32 v96, v96, v111
  v_add_f32 v96, v96, v112
  v_add_f32 v96, v96, v113
  v_add_f32 v96, v96, v114
  v_add_f32 v96, v96, v115
  v_add_f32 v96, v96, v116
  v_add_f32 v96, v96, v117
  v_add_f32 v96, v96, v118
  v_add_f32 v96, v96, v119
  v_add_f32 v96, v96, v120
  v_add_f32 v96, v96, v121
  v_add_f32 v96, v96, v122
  v_add_f32 v96, v96, v123
  v_add_f32 v96, v96, v124
  v_add_f32 v96, v96, v125
  v_add_f32 v96, v96, v126
  v_add_f32 v96, v96, v127
  buffer_store_dword v96, v25, s[32:35], s48 offen
A_nf1:
  v_and_b32 v24, 15, v1
  v_lshlrev_b32 v24, 5, v24
  s_waitcnt lgkmcnt(0)
  s_barrier
  ds_read_b128 v[96:99], v24 offset:32768
  ds_read_b128 v[100:103], v24 offset:32784
  ds_read_b128 v[104:107], v24 offset:33280
  ds_read_b128 v[108:111], v24 offset:33296
  ds_read_b128 v[112:115], v24 offset:33792
  ds_read_b128 v[116:119], v24 offset:33808
  ds_read_b128 v[120:123], v24 offset:34304
  ds_read_b128 v[124:127], v24 offset:34320
  s_waitcnt lgkmcnt(0)
  v_mov_b32 v8, v96
  v_mov_b32 v9, v97
  v_mov_b32 v10, v98
  v_mov_b32 v11, v99
  v_mov_b32 v12, v100
  v_mov_b32 v13, v101
  v_mov_b32 v14, v102
  v_mov_b32 v15, v103
  v_add_f32 v8, v8, v104
  v_add_f32 v9, v9, v105
  v_add_f32 v10, v10, v106
  v_add_f32 v11, v11, v107
  v_add_f32 v12, v12, v108
  v_add_f32 v13, v13, v109
  v_add_f32 v14, v14, v110
  v_add_f32 v15, v15, v111
  v_add_f32 v8, v8, v112
  v_add_f32 v9, v9, v113
  v_add_f32 v10, v10, v114
  v_add_f32 v11, v11, v115
  v_add_f32 v12, v12, v116
  v_add_f32 v13, v13, v117
  v_add_f32 v14, v14, v118
  v_add_f32 v15, v15, v119
  v_add_f32 v8, v8, v120
  v_add_f32 v9, v9, v121
  v_add_f32 v10, v10, v122
  v_add_f32 v11, v11, v123
  v_add_f32 v12, v12, v124
  v_add_f32 v13, v13, v125
  v_add_f32 v14, v14, v126
  v_add_f32 v15, v15, v127
  ds_read_b128 v[96:99], v24 offset:34816
  ds_read_b128 v[100:103], v24 offset:34832
  ds_read_b128 v[104:107], v24 offset:35328
  ds_read_b128 v[108:111], v24 offset:35344
  ds_read_b128 v[112:115], v24 offset:35840
  ds_read_b128 v[116:119], v24 offset:35856
  ds_read_b128 v[120:123], v24 offset:36352
  ds_read_b128 v[124:127], v24 offset:36368
  s_waitcnt lgkmcnt(0)
  v_add_f32 v8, v8, v96
  v_add_f32 v9, v9, v97
  v_add_f32 v10, v10, v98
  v_add_f32 v11, v11, v99
  v_add_f32 v12, v12, v100
  v_add_f32 v13, v13, v101
  v_add_f32 v14, v14, v102
  v_add_f32 v15, v15, v103
  v_add_f32 v8, v8, v104
  v_add_f32 v9, v9, v105
  v_add_f32 v10, v10, v106
  v_add_f32 v11, v11, v107
  v_add_f32 v12, v12, v108
  v_add_f32 v13, v13, v109
  v_add_f32 v14, v14, v110
  v_add_f32 v15, v15, v111
  v_add_f32 v8, v8, v112
  v_add_f32 v9, v9, v113
  v_add_f32 v10, v10, v114
  v_add_f32 v11, v11, v115
  v_add_f32 v12, v12, v116
  v_add_f32 v13, v13, v117
  v_add_f32 v14, v14, v118
  v_add_f32 v15, v15, v119
  v_add_f32 v8, v8, v120
  v_add_f32 v9, v9, v121
  v_add_f32 v10, v10, v122
  v_add_f32 v11, v11, v123
  v_add_f32 v12, v12, v124
  v_add_f32 v13, v13, v125
  v_add_f32 v14, v14, v126
  v_add_f32 v15, v15, v127
  v_cvt_pk_bf16_f32 v4, v8, v9
  v_cvt_pk_bf16_f32 v5, v10, v11
  v_cvt_pk_bf16_f32 v6, v12, v13
  v_cvt_pk_bf16_f32 v7, v14, v15
  v_mov_b32 v8, 0
  v_mov_b32 v9, 0
  v_mov_b32 v10, 0
  v_mov_b32 v11, 0
  v_mov_b32 v12, 0
  v_mov_b32 v13, 0
  v_mov_b32 v14, 0
  v_mov_b32 v15, 0
  v_mov_b32 v16, 0xff800000
  v_mov_b32 v17, 0
  s_mov_b32 s44, 0x3db504f3
  s_mov_b32 s45, 0x3fb8aa3b
  s_mov_b32 s46, 0
  s_waitcnt vmcnt(8)
  v_mov_b32 v30, v16
  v_dot2_f32_bf16 v18, v32, v4, 0
  v_dot2_f32_bf16 v19, v36, v4, 0
  v_dot2_f32_bf16 v20, v40, v4, 0
  v_dot2_f32_bf16 v21, v44, v4, 0
  v_dot2_f32_bf16 v22, v48, v4, 0
  v_dot2_f32_bf16 v23, v52, v4, 0
  v_dot2_f32_bf16 v24, v56, v4, 0
  v_dot2_f32_bf16 v25, v60, v4, 0
  v_dot2_f32_bf16 v18, v33, v5, v18
  v_dot2_f32_bf16 v19, v37, v5, v19
  v_dot2_f32_bf16 v20, v41, v5, v20
  v_dot2_f32_bf16 v21, v45, v5, v21
  v_dot2_f32_bf16 v22, v49, v5, v22
  v_dot2_f32_bf16 v23, v53, v5, v23
  v_dot2_f32_bf16 v24, v57, v5, v24
  v_dot2_f32_bf16 v25, v61, v5, v25
  v_dot2_f32_bf16 v18, v34, v6, v18
  v_dot2_f32_bf16 v19, v38, v6, v19
  v_dot2_f32_bf16 v20, v42, v6, v20
  v_dot2_f32_bf16 v21, v46, v6, v21
  v_dot2_f32_bf16 v22, v50, v6, v22
  v_dot2_f32_bf16 v23, v54, v6, v23
  v_dot2_f32_bf16 v24, v58, v6, v24
  v_dot2_f32_bf16 v25, v62, v6, v25
  v_dot2_f32_bf16 v18, v35, v7, v18
  v_dot2_f32_bf16 v19, v39, v7, v19
  v_dot2_f32_bf16 v20, v43, v7, v20
  v_dot2_f32_bf16 v21, v47, v7, v21
  v_dot2_f32_bf16 v22, v51, v7, v22
  v_dot2_f32_bf16 v23, v55, v7, v23
  v_dot2_f32_bf16 v24, v59, v7, v24
  v_dot2_f32_bf16 v25, v63, v7, v25
  s_add_u32 s46, s36, 262144
  buffer_load_dwordx4 v[32:35], v2, s[16:19], s46 offen offset:0 nt
  buffer_load_dwordx4 v[36:39], v2, s[16:19], s46 offen offset:1024 nt
  buffer_load_dwordx4 v[40:43], v2, s[16:19], s46 offen offset:2048 nt
  buffer_load_dwordx4 v[44:47], v2, s[16:19], s46 offen offset:3072 nt
  buffer_load_dwordx4 v[48:51], v3, s[16:19], s46 offen offset:0 nt
  buffer_load_dwordx4 v[52:55], v3, s[16:19], s46 offen offset:1024 nt
  buffer_load_dwordx4 v[56:59], v3, s[16:19], s46 offen offset:2048 nt
  buffer_load_dwordx4 v[60:63], v3, s[16:19], s46 offen offset:3072 nt
  v_add_f32_dpp v18, v18, v18 row_ror:8 row_mask:0xf bank_mask:0xf
  v_add_f32_dpp v19, v19, v19 row_ror:8 row_mask:0xf bank_mask:0xf
  v_add_f32_dpp v20, v20, v20 row_ror:8 row_mask:0xf bank_mask:0xf
  v_add_f32_dpp v21, v21, v21 row_ror:8 row_mask:0xf bank_mask:0xf
  v_add_f32_dpp v22, v22, v22 row_ror:8 row_mask:0xf bank_mask:0xf
  v_add_f32_dpp v23, v23, v23 row_ror:8 row_mask:0xf bank_mask:0xf
  v_add_f32_dpp v24, v24, v24 row_ror:8 row_mask:0xf bank_mask:0xf
  v_add_f32_dpp v25, v25, v25 row_ror:8 row_mask:0xf bank_mask:0xf
  v_add_f32_dpp v18, v18, v18 row_ror:4 row_mask:0xf bank_mask:0xf
  v_add_f32_dpp v19, v19, v19 row_ror:4 row_mask:0xf bank_mask:0xf
  v_add_f32_dpp v20, v20, v20 row_ror:4 row_mask:0xf bank_mask:0xf
  v_add_f32_dpp v21, v21, v21 row_ror:4 row_mask:0xf bank_mask:0xf
  v_add_f32_dpp v22, v22, v22 row_ror:4 row_mask:0xf bank_mask:0xf
  v_add_f32_dpp v23, v23, v23 row_ror:4 row_mask:0xf bank_mask:0xf
  v_add_f32_dpp v24, v24, v24 row_ror:4 row_mask:0xf bank_mask:0xf
  v_add_f32_dpp v25, v25, v25 row_ror:4 row_mask:0xf bank_mask:0xf
  v_add_f32_dpp v18, v18, v18 row_ror:2 row_mask:0xf bank_mask:0xf
  v_add_f32_dpp v19, v19, v19 row_ror:2 row_mask:0xf bank_mask:0xf
  v_add_f32_dpp v20, v20, v20 row_ror:2 row_mask:0xf bank_mask:0xf
  v_add_f32_dpp v21, v21, v21 row_ror:2 row_mask:0xf bank_mask:0xf
  v_add_f32_dpp v22, v22, v22 row_ror:2 row_mask:0xf bank_mask:0xf
  v_add_f32_dpp v23, v23, v23 row_ror:2 row_mask:0xf bank_mask:0xf
  v_add_f32_dpp v24, v24, v24 row_ror:2 row_mask:0xf bank_mask:0xf
  v_add_f32_dpp v25, v25, v25 row_ror:2 row_mask:0xf bank_mask:0xf
  v_add_f32_dpp v18, v18, v18 row_ror:1 row_mask:0xf bank_mask:0xf
  v_add_f32_dpp v19, v19, v19 row_ror:1 row_mask:0xf bank_mask:0xf
  v_add_f32_dpp v20, v20, v20 row_ror:1 row_mask:0xf bank_mask:0xf
  v_add_f32_dpp v21, v21, v21 row_ror:1 row_mask:0xf bank_mask:0xf
  v_add_f32_dpp v22, v22, v22 row_ror:1 row_mask:0xf bank_mask:0xf
  v_add_f32_dpp v23, v23, v23 row_ror:1 row_mask:0xf bank_mask:0xf
  v_add_f32_dpp v24, v24, v24 row_ror:1 row_mask:0xf bank_mask:0xf
  v_add_f32_dpp v25, v25, v25 row_ror:1 row_mask:0xf bank_mask:0xf
  v_cvt_pk_bf16_f32 v26, v18, v19
  v_cvt_pk_bf16_f32 v27, v20, v21
  v_cvt_pk_bf16_f32 v28, v22, v23
  v_cvt_pk_bf16_f32 v29, v24, v25
  v_lshlrev_b32 v18, 16, v26
  v_and_b32 v19, 0xffff0000, v26
  v_lshlrev_b32 v20, 16, v27
  v_and_b32 v21, 0xffff0000, v27
  v_lshlrev_b32 v22, 16, v28
  v_and_b32 v23, 0xffff0000, v28
  v_lshlrev_b32 v24, 16, v29
  v_and_b32 v25, 0xffff0000, v29
  v_mul_f32 v18, s44, v18
  v_mul_f32 v19, s44, v19
  v_mul_f32 v20, s44, v20
  v_mul_f32 v21, s44, v21
  v_mul_f32 v22, s44, v22
  v_mul_f32 v23, s44, v23
  v_mul_f32 v24, s44, v24
  v_mul_f32 v25, s44, v25
  v_cvt_pk_bf16_f32 v96, v18, v19
  v_max3_f32 v30, v30, v18, v19
  v_cvt_pk_bf16_f32 v97, v20, v21
  v_max3_f32 v30, v30, v20, v21
  v_cvt_pk_bf16_f32 v98, v22, v23
  v_max3_f32 v30, v30, v22, v23
  v_cvt_pk_bf16_f32 v99, v24, v25
  v_max3_f32 v30, v30, v24, v25
  s_waitcnt vmcnt(8)
  v_dot2_f32_bf16 v18, v64, v4, 0
  v_dot2_f32_bf16 v19, v68, v4, 0
  v_dot2_f32_bf16 v20, v72, v4, 0
  v_dot2_f32_bf16 v21, v76, v4, 0
  v_dot2_f32_bf16 v22, v80, v4, 0
  v_dot2_f32_bf16 v23, v84, v4, 0
  v_dot2_f32_bf16 v24, v88, v4, 0
  v_dot2_f32_bf16 v25, v92, v4, 0
  v_dot2_f32_bf16 v18, v65, v5, v18
  v_dot2_f32_bf16 v19, v69, v5, v19
  v_dot2_f32_bf16 v20, v73, v5, v20
  v_dot2_f32_bf16 v21, v77, v5, v21
  v_dot2_f32_bf16 v22, v81, v5, v22
  v_dot2_f32_bf16 v23, v85, v5, v23
  v_dot2_f32_bf16 v24, v89, v5, v24
  v_dot2_f32_bf16 v25, v93, v5, v25
  v_dot2_f32_bf16 v18, v66, v6, v18
  v_dot2_f32_bf16 v19, v70, v6, v19
  v_dot2_f32_bf16 v20, v74, v6, v20
  v_dot2_f32_bf16 v21, v78, v6, v21
  v_dot2_f32_bf16 v22, v82, v6, v22
  v_dot2_f32_bf16 v23, v86, v6, v23
  v_dot2_f32_bf16 v24, v90, v6, v24
  v_dot2_f32_bf16 v25, v94, v6, v25
  v_dot2_f32_bf16 v18, v67, v7, v18
  v_dot2_f32_bf16 v19, v71, v7, v19
  v_dot2_f32_bf16 v20, v75, v7, v20
  v_dot2_f32_bf16 v21, v79, v7, v21
  v_dot2_f32_bf16 v22, v83, v7, v22
  v_dot2_f32_bf16 v23, v87, v7, v23
  v_dot2_f32_bf16 v24, v91, v7, v24
  v_dot2_f32_bf16 v25, v95, v7, v25
  s_add_u32 s46, s36, 393216
  buffer_load_dwordx4 v[64:67], v2, s[16:19], s46 offen offset:0 nt
  buffer_load_dwordx4 v[68:71], v2, s[16:19], s46 offen offset:1024 nt
  buffer_load_dwordx4 v[72:75], v2, s[16:19], s46 offen offset:2048 nt
  buffer_load_dwordx4 v[76:79], v2, s[16:19], s46 offen offset:3072 nt
  buffer_load_dwordx4 v[80:83], v3, s[16:19], s46 offen offset:0 nt
  buffer_load_dwordx4 v[84:87], v3, s[16:19], s46 offen offset:1024 nt
  buffer_load_dwordx4 v[88:91], v3, s[16:19], s46 offen offset:2048 nt
  buffer_load_dwordx4 v[92:95], v3, s[16:19], s46 offen offset:3072 nt
  v_add_f32_dpp v18, v18, v18 row_ror:8 row_mask:0xf bank_mask:0xf
  v_add_f32_dpp v19, v19, v19 row_ror:8 row_mask:0xf bank_mask:0xf
  v_add_f32_dpp v20, v20, v20 row_ror:8 row_mask:0xf bank_mask:0xf
  v_add_f32_dpp v21, v21, v21 row_ror:8 row_mask:0xf bank_mask:0xf
  v_add_f32_dpp v22, v22, v22 row_ror:8 row_mask:0xf bank_mask:0xf
  v_add_f32_dpp v23, v23, v23 row_ror:8 row_mask:0xf bank_mask:0xf
  v_add_f32_dpp v24, v24, v24 row_ror:8 row_mask:0xf bank_mask:0xf
  v_add_f32_dpp v25, v25, v25 row_ror:8 row_mask:0xf bank_mask:0xf
  v_add_f32_dpp v18, v18, v18 row_ror:4 row_mask:0xf bank_mask:0xf
  v_add_f32_dpp v19, v19, v19 row_ror:4 row_mask:0xf bank_mask:0xf
  v_add_f32_dpp v20, v20, v20 row_ror:4 row_mask:0xf bank_mask:0xf
  v_add_f32_dpp v21, v21, v21 row_ror:4 row_mask:0xf bank_mask:0xf
  v_add_f32_dpp v22, v22, v22 row_ror:4 row_mask:0xf bank_mask:0xf
  v_add_f32_dpp v23, v23, v23 row_ror:4 row_mask:0xf bank_mask:0xf
  v_add_f32_dpp v24, v24, v24 row_ror:4 row_mask:0xf bank_mask:0xf
  v_add_f32_dpp v25, v25, v25 row_ror:4 row_mask:0xf bank_mask:0xf
  v_add_f32_dpp v18, v18, v18 row_ror:2 row_mask:0xf bank_mask:0xf
  v_add_f32_dpp v19, v19, v19 row_ror:2 row_mask:0xf bank_mask:0xf
  v_add_f32_dpp v20, v20, v20 row_ror:2 row_mask:0xf bank_mask:0xf
  v_add_f32_dpp v21, v21, v21 row_ror:2 row_mask:0xf bank_mask:0xf
  v_add_f32_dpp v22, v22, v22 row_ror:2 row_mask:0xf bank_mask:0xf
  v_add_f32_dpp v23, v23, v23 row_ror:2 row_mask:0xf bank_mask:0xf
  v_add_f32_dpp v24, v24, v24 row_ror:2 row_mask:0xf bank_mask:0xf
  v_add_f32_dpp v25, v25, v25 row_ror:2 row_mask:0xf bank_mask:0xf
  v_add_f32_dpp v18, v18, v18 row_ror:1 row_mask:0xf bank_mask:0xf
  v_add_f32_dpp v19, v19, v19 row_ror:1 row_mask:0xf bank_mask:0xf
  v_add_f32_dpp v20, v20, v20 row_ror:1 row_mask:0xf bank_mask:0xf
  v_add_f32_dpp v21, v21, v21 row_ror:1 row_mask:0xf bank_mask:0xf
  v_add_f32_dpp v22, v22, v22 row_ror:1 row_mask:0xf bank_mask:0xf
  v_add_f32_dpp v23, v23, v23 row_ror:1 row_mask:0xf bank_mask:0xf
  v_add_f32_dpp v24, v24, v24 row_ror:1 row_mask:0xf bank_mask:0xf
  v_add_f32_dpp v25, v25, v25 row_ror:1 row_mask:0xf bank_mask:0xf
  v_cvt_pk_bf16_f32 v26, v18, v19
  v_cvt_pk_bf16_f32 v27, v20, v21
  v_cvt_pk_bf16_f32 v28, v22, v23
  v_cvt_pk_bf16_f32 v29, v24, v25
  v_lshlrev_b32 v18, 16, v26
  v_and_b32 v19, 0xffff0000, v26
  v_lshlrev_b32 v20, 16, v27
  v_and_b32 v21, 0xffff0000, v27
  v_lshlrev_b32 v22, 16, v28
  v_and_b32 v23, 0xffff0000, v28
  v_lshlrev_b32 v24, 16, v29
  v_and_b32 v25, 0xffff0000, v29
  v_mul_f32 v18, s44, v18
  v_mul_f32 v19, s44, v19
  v_mul_f32 v20, s44, v20
  v_mul_f32 v21, s44, v21
  v_mul_f32 v22, s44, v22
  v_mul_f32 v23, s44, v23
  v_mul_f32 v24, s44, v24
  v_mul_f32 v25, s44, v25
  v_cvt_pk_bf16_f32 v100, v18, v19
  v_max3_f32 v30, v30, v18, v19
  v_cvt_pk_bf16_f32 v101, v20, v21
  v_max3_f32 v30, v30, v20, v21
  v_cvt_pk_bf16_f32 v102, v22, v23
  v_max3_f32 v30, v30, v22, v23
  v_cvt_pk_bf16_f32 v103, v24, v25
  v_max3_f32 v30, v30, v24, v25
  s_waitcnt vmcnt(8)
  v_dot2_f32_bf16 v18, v32, v4, 0
  v_dot2_f32_bf16 v19, v36, v4, 0
  v_dot2_f32_bf16 v20, v40, v4, 0
  v_dot2_f32_bf16 v21, v44, v4, 0
  v_dot2_f32_bf16 v22, v48, v4, 0
  v_dot2_f32_bf16 v23, v52, v4, 0
  v_dot2_f32_bf16 v24, v56, v4, 0
  v_dot2_f32_bf16 v25, v60, v4, 0
  v_dot2_f32_bf16 v18, v33, v5, v18
  v_dot2_f32_bf16 v19, v37, v5, v19
  v_dot2_f32_bf16 v20, v41, v5, v20
  v_dot2_f32_bf16 v21, v45, v5, v21
  v_dot2_f32_bf16 v22, v49, v5, v22
  v_dot2_f32_bf16 v23, v53, v5, v23
  v_dot2_f32_bf16 v24, v57, v5, v24
  v_dot2_f32_bf16 v25, v61, v5, v25
  v_dot2_f32_bf16 v18, v34, v6, v18
  v_dot2_f32_bf16 v19, v38, v6, v19
  v_dot2_f32_bf16 v20, v42, v6, v20
  v_dot2_f32_bf16 v21, v46, v6, v21
  v_dot2_f32_bf16 v22, v50, v6, v22
  v_dot2_f32_bf16 v23, v54, v6, v23
  v_dot2_f32_bf16 v24, v58, v6, v24
  v_dot2_f32_bf16 v25, v62, v6, v25
  v_dot2_f32_bf16 v18, v35, v7, v18
  v_dot2_f32_bf16 v19, v39, v7, v19
  v_dot2_f32_bf16 v20, v43, v7, v20
  v_dot2_f32_bf16 v21, v47, v7, v21
  v_dot2_f32_bf16 v22, v51, v7, v22
  v_dot2_f32_bf16 v23, v55, v7, v23
  v_dot2_f32_bf16 v24, v59, v7, v24
  v_dot2_f32_bf16 v25, v63, v7, v25
  s_add_u32 s46, s36, 524288
  buffer_load_dwordx4 v[32:35], v2, s[16:19], s46 offen offset:0 nt
  buffer_load_dwordx4 v[36:39], v2, s[16:19], s46 offen offset:1024 nt
  buffer_load_dwordx4 v[40:43], v2, s[16:19], s46 offen offset:2048 nt
  buffer_load_dwordx4 v[44:47], v2, s[16:19], s46 offen offset:3072 nt
  buffer_load_dwordx4 v[48:51], v3, s[16:19], s46 offen offset:0 nt
  buffer_load_dwordx4 v[52:55], v3, s[16:19], s46 offen offset:1024 nt
  buffer_load_dwordx4 v[56:59], v3, s[16:19], s46 offen offset:2048 nt
  buffer_load_dwordx4 v[60:63], v3, s[16:19], s46 offen offset:3072 nt
  v_add_f32_dpp v18, v18, v18 row_ror:8 row_mask:0xf bank_mask:0xf
  v_add_f32_dpp v19, v19, v19 row_ror:8 row_mask:0xf bank_mask:0xf
  v_add_f32_dpp v20, v20, v20 row_ror:8 row_mask:0xf bank_mask:0xf
  v_add_f32_dpp v21, v21, v21 row_ror:8 row_mask:0xf bank_mask:0xf
  v_add_f32_dpp v22, v22, v22 row_ror:8 row_mask:0xf bank_mask:0xf
  v_add_f32_dpp v23, v23, v23 row_ror:8 row_mask:0xf bank_mask:0xf
  v_add_f32_dpp v24, v24, v24 row_ror:8 row_mask:0xf bank_mask:0xf
  v_add_f32_dpp v25, v25, v25 row_ror:8 row_mask:0xf bank_mask:0xf
  v_add_f32_dpp v18, v18, v18 row_ror:4 row_mask:0xf bank_mask:0xf
  v_add_f32_dpp v19, v19, v19 row_ror:4 row_mask:0xf bank_mask:0xf
  v_add_f32_dpp v20, v20, v20 row_ror:4 row_mask:0xf bank_mask:0xf
  v_add_f32_dpp v21, v21, v21 row_ror:4 row_mask:0xf bank_mask:0xf
  v_add_f32_dpp v22, v22, v22 row_ror:4 row_mask:0xf bank_mask:0xf
  v_add_f32_dpp v23, v23, v23 row_ror:4 row_mask:0xf bank_mask:0xf
  v_add_f32_dpp v24, v24, v24 row_ror:4 row_mask:0xf bank_mask:0xf
  v_add_f32_dpp v25, v25, v25 row_ror:4 row_mask:0xf bank_mask:0xf
  v_add_f32_dpp v18, v18, v18 row_ror:2 row_mask:0xf bank_mask:0xf
  v_add_f32_dpp v19, v19, v19 row_ror:2 row_mask:0xf bank_mask:0xf
  v_add_f32_dpp v20, v20, v20 row_ror:2 row_mask:0xf bank_mask:0xf
  v_add_f32_dpp v21, v21, v21 row_ror:2 row_mask:0xf bank_mask:0xf
  v_add_f32_dpp v22, v22, v22 row_ror:2 row_mask:0xf bank_mask:0xf
  v_add_f32_dpp v23, v23, v23 row_ror:2 row_mask:0xf bank_mask:0xf
  v_add_f32_dpp v24, v24, v24 row_ror:2 row_mask:0xf bank_mask:0xf
  v_add_f32_dpp v25, v25, v25 row_ror:2 row_mask:0xf bank_mask:0xf
  v_add_f32_dpp v18, v18, v18 row_ror:1 row_mask:0xf bank_mask:0xf
  v_add_f32_dpp v19, v19, v19 row_ror:1 row_mask:0xf bank_mask:0xf
  v_add_f32_dpp v20, v20, v20 row_ror:1 row_mask:0xf bank_mask:0xf
  v_add_f32_dpp v21, v21, v21 row_ror:1 row_mask:0xf bank_mask:0xf
  v_add_f32_dpp v22, v22, v22 row_ror:1 row_mask:0xf bank_mask:0xf
  v_add_f32_dpp v23, v23, v23 row_ror:1 row_mask:0xf bank_mask:0xf
  v_add_f32_dpp v24, v24, v24 row_ror:1 row_mask:0xf bank_mask:0xf
  v_add_f32_dpp v25, v25, v25 row_ror:1 row_mask:0xf bank_mask:0xf
  v_cvt_pk_bf16_f32 v26, v18, v19
  v_cvt_pk_bf16_f32 v27, v20, v21
  v_cvt_pk_bf16_f32 v28, v22, v23
  v_cvt_pk_bf16_f32 v29, v24, v25
  v_lshlrev_b32 v18, 16, v26
  v_and_b32 v19, 0xffff0000, v26
  v_lshlrev_b32 v20, 16, v27
  v_and_b32 v21, 0xffff0000, v27
  v_lshlrev_b32 v22, 16, v28
  v_and_b32 v23, 0xffff0000, v28
  v_lshlrev_b32 v24, 16, v29
  v_and_b32 v25, 0xffff0000, v29
  v_mul_f32 v18, s44, v18
  v_mul_f32 v19, s44, v19
  v_mul_f32 v20, s44, v20
  v_mul_f32 v21, s44, v21
  v_mul_f32 v22, s44, v22
  v_mul_f32 v23, s44, v23
  v_mul_f32 v24, s44, v24
  v_mul_f32 v25, s44, v25
  v_cvt_pk_bf16_f32 v104, v18, v19
  v_max3_f32 v30, v30, v18, v19
  v_cvt_pk_bf16_f32 v105, v20, v21
  v_max3_f32 v30, v30, v20, v21
  v_cvt_pk_bf16_f32 v106, v22, v23
  v_max3_f32 v30, v30, v22, v23
  v_cvt_pk_bf16_f32 v107, v24, v25
  v_max3_f32 v30, v30, v24, v25
  s_waitcnt vmcnt(8)
  v_dot2_f32_bf16 v18, v64, v4, 0
  v_dot2_f32_bf16 v19, v68, v4, 0
  v_dot2_f32_bf16 v20, v72, v4, 0
  v_dot2_f32_bf16 v21, v76, v4, 0
  v_dot2_f32_bf16 v22, v80, v4, 0
  v_dot2_f32_bf16 v23, v84, v4, 0
  v_dot2_f32_bf16 v24, v88, v4, 0
  v_dot2_f32_bf16 v25, v92, v4, 0
  v_dot2_f32_bf16 v18, v65, v5, v18
  v_dot2_f32_bf16 v19, v69, v5, v19
  v_dot2_f32_bf16 v20, v73, v5, v20
  v_dot2_f32_bf16 v21, v77, v5, v21
  v_dot2_f32_bf16 v22, v81, v5, v22
  v_dot2_f32_bf16 v23, v85, v5, v23
  v_dot2_f32_bf16 v24, v89, v5, v24
  v_dot2_f32_bf16 v25, v93, v5, v25
  v_dot2_f32_bf16 v18, v66, v6, v18
  v_dot2_f32_bf16 v19, v70, v6, v19
  v_dot2_f32_bf16 v20, v74, v6, v20
  v_dot2_f32_bf16 v21, v78, v6, v21
  v_dot2_f32_bf16 v22, v82, v6, v22
  v_dot2_f32_bf16 v23, v86, v6, v23
  v_dot2_f32_bf16 v24, v90, v6, v24
  v_dot2_f32_bf16 v25, v94, v6, v25
  v_dot2_f32_bf16 v18, v67, v7, v18
  v_dot2_f32_bf16 v19, v71, v7, v19
  v_dot2_f32_bf16 v20, v75, v7, v20
  v_dot2_f32_bf16 v21, v79, v7, v21
  v_dot2_f32_bf16 v22, v83, v7, v22
  v_dot2_f32_bf16 v23, v87, v7, v23
  v_dot2_f32_bf16 v24, v91, v7, v24
  v_dot2_f32_bf16 v25, v95, v7, v25
  s_add_u32 s46, s36, 655360
  buffer_load_dwordx4 v[64:67], v2, s[16:19], s46 offen offset:0 nt
  buffer_load_dwordx4 v[68:71], v2, s[16:19], s46 offen offset:1024 nt
  buffer_load_dwordx4 v[72:75], v2, s[16:19], s46 offen offset:2048 nt
  buffer_load_dwordx4 v[76:79], v2, s[16:19], s46 offen offset:3072 nt
  buffer_load_dwordx4 v[80:83], v3, s[16:19], s46 offen offset:0 nt
  buffer_load_dwordx4 v[84:87], v3, s[16:19], s46 offen offset:1024 nt
  buffer_load_dwordx4 v[88:91], v3, s[16:19], s46 offen offset:2048 nt
  buffer_load_dwordx4 v[92:95], v3, s[16:19], s46 offen offset:3072 nt
  v_add_f32_dpp v18, v18, v18 row_ror:8 row_mask:0xf bank_mask:0xf
  v_add_f32_dpp v19, v19, v19 row_ror:8 row_mask:0xf bank_mask:0xf
  v_add_f32_dpp v20, v20, v20 row_ror:8 row_mask:0xf bank_mask:0xf
  v_add_f32_dpp v21, v21, v21 row_ror:8 row_mask:0xf bank_mask:0xf
  v_add_f32_dpp v22, v22, v22 row_ror:8 row_mask:0xf bank_mask:0xf
  v_add_f32_dpp v23, v23, v23 row_ror:8 row_mask:0xf bank_mask:0xf
  v_add_f32_dpp v24, v24, v24 row_ror:8 row_mask:0xf bank_mask:0xf
  v_add_f32_dpp v25, v25, v25 row_ror:8 row_mask:0xf bank_mask:0xf
  v_add_f32_dpp v18, v18, v18 row_ror:4 row_mask:0xf bank_mask:0xf
  v_add_f32_dpp v19, v19, v19 row_ror:4 row_mask:0xf bank_mask:0xf
  v_add_f32_dpp v20, v20, v20 row_ror:4 row_mask:0xf bank_mask:0xf
  v_add_f32_dpp v21, v21, v21 row_ror:4 row_mask:0xf bank_mask:0xf
  v_add_f32_dpp v22, v22, v22 row_ror:4 row_mask:0xf bank_mask:0xf
  v_add_f32_dpp v23, v23, v23 row_ror:4 row_mask:0xf bank_mask:0xf
  v_add_f32_dpp v24, v24, v24 row_ror:4 row_mask:0xf bank_mask:0xf
  v_add_f32_dpp v25, v25, v25 row_ror:4 row_mask:0xf bank_mask:0xf
  v_add_f32_dpp v18, v18, v18 row_ror:2 row_mask:0xf bank_mask:0xf
  v_add_f32_dpp v19, v19, v19 row_ror:2 row_mask:0xf bank_mask:0xf
  v_add_f32_dpp v20, v20, v20 row_ror:2 row_mask:0xf bank_mask:0xf
  v_add_f32_dpp v21, v21, v21 row_ror:2 row_mask:0xf bank_mask:0xf
  v_add_f32_dpp v22, v22, v22 row_ror:2 row_mask:0xf bank_mask:0xf
  v_add_f32_dpp v23, v23, v23 row_ror:2 row_mask:0xf bank_mask:0xf
  v_add_f32_dpp v24, v24, v24 row_ror:2 row_mask:0xf bank_mask:0xf
  v_add_f32_dpp v25, v25, v25 row_ror:2 row_mask:0xf bank_mask:0xf
  v_add_f32_dpp v18, v18, v18 row_ror:1 row_mask:0xf bank_mask:0xf
  v_add_f32_dpp v19, v19, v19 row_ror:1 row_mask:0xf bank_mask:0xf
  v_add_f32_dpp v20, v20, v20 row_ror:1 row_mask:0xf bank_mask:0xf
  v_add_f32_dpp v21, v21, v21 row_ror:1 row_mask:0xf bank_mask:0xf
  v_add_f32_dpp v22, v22, v22 row_ror:1 row_mask:0xf bank_mask:0xf
  v_add_f32_dpp v23, v23, v23 row_ror:1 row_mask:0xf bank_mask:0xf
  v_add_f32_dpp v24, v24, v24 row_ror:1 row_mask:0xf bank_mask:0xf
  v_add_f32_dpp v25, v25, v25 row_ror:1 row_mask:0xf bank_mask:0xf
  v_cvt_pk_bf16_f32 v26, v18, v19
  v_cvt_pk_bf16_f32 v27, v20, v21
  v_cvt_pk_bf16_f32 v28, v22, v23
  v_cvt_pk_bf16_f32 v29, v24, v25
  v_lshlrev_b32 v18, 16, v26
  v_and_b32 v19, 0xffff0000, v26
  v_lshlrev_b32 v20, 16, v27
  v_and_b32 v21, 0xffff0000, v27
  v_lshlrev_b32 v22, 16, v28
  v_and_b32 v23, 0xffff0000, v28
  v_lshlrev_b32 v24, 16, v29
  v_and_b32 v25, 0xffff0000, v29
  v_mul_f32 v18, s44, v18
  v_mul_f32 v19, s44, v19
  v_mul_f32 v20, s44, v20
  v_mul_f32 v21, s44, v21
  v_mul_f32 v22, s44, v22
  v_mul_f32 v23, s44, v23
  v_mul_f32 v24, s44, v24
  v_mul_f32 v25, s44, v25
  v_cvt_pk_bf16_f32 v108, v18, v19
  v_max3_f32 v30, v30, v18, v19
  v_cvt_pk_bf16_f32 v109, v20, v21
  v_max3_f32 v30, v30, v20, v21
  v_cvt_pk_bf16_f32 v110, v22, v23
  v_max3_f32 v30, v30, v22, v23
  v_cvt_pk_bf16_f32 v111, v24, v25
  v_max3_f32 v30, v30, v24, v25
  s_waitcnt vmcnt(8)
  v_dot2_f32_bf16 v18, v32, v4, 0
  v_dot2_f32_bf16 v19, v36, v4, 0
  v_dot2_f32_bf16 v20, v40, v4, 0
  v_dot2_f32_bf16 v21, v44, v4, 0
  v_dot2_f32_bf16 v22, v48, v4, 0
  v_dot2_f32_bf16 v23, v52, v4, 0
  v_dot2_f32_bf16 v24, v56, v4, 0
  v_dot2_f32_bf16 v25, v60, v4, 0
  v_dot2_f32_bf16 v18, v33, v5, v18
  v_dot2_f32_bf16 v19, v37, v5, v19
  v_dot2_f32_bf16 v20, v41, v5, v20
  v_dot2_f32_bf16 v21, v45, v5, v21
  v_dot2_f32_bf16 v22, v49, v5, v22
  v_dot2_f32_bf16 v23, v53, v5, v23
  v_dot2_f32_bf16 v24, v57, v5, v24
  v_dot2_f32_bf16 v25, v61, v5, v25
  v_dot2_f32_bf16 v18, v34, v6, v18
  v_dot2_f32_bf16 v19, v38, v6, v19
  v_dot2_f32_bf16 v20, v42, v6, v20
  v_dot2_f32_bf16 v21, v46, v6, v21
  v_dot2_f32_bf16 v22, v50, v6, v22
  v_dot2_f32_bf16 v23, v54, v6, v23
  v_dot2_f32_bf16 v24, v58, v6, v24
  v_dot2_f32_bf16 v25, v62, v6, v25
  v_dot2_f32_bf16 v18, v35, v7, v18
  v_dot2_f32_bf16 v19, v39, v7, v19
  v_dot2_f32_bf16 v20, v43, v7, v20
  v_dot2_f32_bf16 v21, v47, v7, v21
  v_dot2_f32_bf16 v22, v51, v7, v22
  v_dot2_f32_bf16 v23, v55, v7, v23
  v_dot2_f32_bf16 v24, v59, v7, v24
  v_dot2_f32_bf16 v25, v63, v7, v25
  s_add_u32 s46, s36, 786432
  buffer_load_dwordx4 v[32:35], v2, s[16:19], s46 offen offset:0 nt
  buffer_load_dwordx4 v[36:39], v2, s[16:19], s46 offen offset:1024 nt
  buffer_load_dwordx4 v[40:43], v2, s[16:19], s46 offen offset:2048 nt
  buffer_load_dwordx4 v[44:47], v2, s[16:19], s46 offen offset:3072 nt
  buffer_load_dwordx4 v[48:51], v3, s[16:19], s46 offen offset:0 nt
  buffer_load_dwordx4 v[52:55], v3, s[16:19], s46 offen offset:1024 nt
  buffer_load_dwordx4 v[56:59], v3, s[16:19], s46 offen offset:2048 nt
  buffer_load_dwordx4 v[60:63], v3, s[16:19], s46 offen offset:3072 nt
  v_add_f32_dpp v18, v18, v18 row_ror:8 row_mask:0xf bank_mask:0xf
  v_add_f32_dpp v19, v19, v19 row_ror:8 row_mask:0xf bank_mask:0xf
  v_add_f32_dpp v20, v20, v20 row_ror:8 row_mask:0xf bank_mask:0xf
  v_add_f32_dpp v21, v21, v21 row_ror:8 row_mask:0xf bank_mask:0xf
  v_add_f32_dpp v22, v22, v22 row_ror:8 row_mask:0xf bank_mask:0xf
  v_add_f32_dpp v23, v23, v23 row_ror:8 row_mask:0xf bank_mask:0xf
  v_add_f32_dpp v24, v24, v24 row_ror:8 row_mask:0xf bank_mask:0xf
  v_add_f32_dpp v25, v25, v25 row_ror:8 row_mask:0xf bank_mask:0xf
  v_add_f32_dpp v18, v18, v18 row_ror:4 row_mask:0xf bank_mask:0xf
  v_add_f32_dpp v19, v19, v19 row_ror:4 row_mask:0xf bank_mask:0xf
  v_add_f32_dpp v20, v20, v20 row_ror:4 row_mask:0xf bank_mask:0xf
  v_add_f32_dpp v21, v21, v21 row_ror:4 row_mask:0xf bank_mask:0xf
  v_add_f32_dpp v22, v22, v22 row_ror:4 row_mask:0xf bank_mask:0xf
  v_add_f32_dpp v23, v23, v23 row_ror:4 row_mask:0xf bank_mask:0xf
  v_add_f32_dpp v24, v24, v24 row_ror:4 row_mask:0xf bank_mask:0xf
  v_add_f32_dpp v25, v25, v25 row_ror:4 row_mask:0xf bank_mask:0xf
  v_add_f32_dpp v18, v18, v18 row_ror:2 row_mask:0xf bank_mask:0xf
  v_add_f32_dpp v19, v19, v19 row_ror:2 row_mask:0xf bank_mask:0xf
  v_add_f32_dpp v20, v20, v20 row_ror:2 row_mask:0xf bank_mask:0xf
  v_add_f32_dpp v21, v21, v21 row_ror:2 row_mask:0xf bank_mask:0xf
  v_add_f32_dpp v22, v22, v22 row_ror:2 row_mask:0xf bank_mask:0xf
  v_add_f32_dpp v23, v23, v23 row_ror:2 row_mask:0xf bank_mask:0xf
  v_add_f32_dpp v24, v24, v24 row_ror:2 row_mask:0xf bank_mask:0xf
  v_add_f32_dpp v25, v25, v25 row_ror:2 row_mask:0xf bank_mask:0xf
  v_add_f32_dpp v18, v18, v18 row_ror:1 row_mask:0xf bank_mask:0xf
  v_add_f32_dpp v19, v19, v19 row_ror:1 row_mask:0xf bank_mask:0xf
  v_add_f32_dpp v20, v20, v20 row_ror:1 row_mask:0xf bank_mask:0xf
  v_add_f32_dpp v21, v21, v21 row_ror:1 row_mask:0xf bank_mask:0xf
  v_add_f32_dpp v22, v22, v22 row_ror:1 row_mask:0xf bank_mask:0xf
  v_add_f32_dpp v23, v23, v23 row_ror:1 row_mask:0xf bank_mask:0xf
  v_add_f32_dpp v24, v24, v24 row_ror:1 row_mask:0xf bank_mask:0xf
  v_add_f32_dpp v25, v25, v25 row_ror:1 row_mask:0xf bank_mask:0xf
  v_cvt_pk_bf16_f32 v26, v18, v19
  v_cvt_pk_bf16_f32 v27, v20, v21
  v_cvt_pk_bf16_f32 v28, v22, v23
  v_cvt_pk_bf16_f32 v29, v24, v25
  v_lshlrev_b32 v18, 16, v26
  v_and_b32 v19, 0xffff0000, v26
  v_lshlrev_b32 v20, 16, v27
  v_and_b32 v21, 0xffff0000, v27
  v_lshlrev_b32 v22, 16, v28
  v_and_b32 v23, 0xffff0000, v28
  v_lshlrev_b32 v24, 16, v29
  v_and_b32 v25, 0xffff0000, v29
  v_mul_f32 v18, s44, v18
  v_mul_f32 v19, s44, v19
  v_mul_f32 v20, s44, v20
  v_mul_f32 v21, s44, v21
  v_mul_f32 v22, s44, v22
  v_mul_f32 v23, s44, v23
  v_mul_f32 v24, s44, v24
  v_mul_f32 v25, s44, v25
  v_cvt_pk_bf16_f32 v112, v18, v19
  v_max3_f32 v30, v30, v18, v19
  v_cvt_pk_bf16_f32 v113, v20, v21
  v_max3_f32 v30, v30, v20, v21
  v_cvt_pk_bf16_f32 v114, v22, v23
  v_max3_f32 v30, v30, v22, v23
  v_cvt_pk_bf16_f32 v115, v24, v25
  v_max3_f32 v30, v30, v24, v25
  s_waitcnt vmcnt(8)
  v_dot2_f32_bf16 v18, v64, v4, 0
  v_dot2_f32_bf16 v19, v68, v4, 0
  v_dot2_f32_bf16 v20, v72, v4, 0
  v_dot2_f32_bf16 v21, v76, v4, 0
  v_dot2_f32_bf16 v22, v80, v4, 0
  v_dot2_f32_bf16 v23, v84, v4, 0
  v_dot2_f32_bf16 v24, v88, v4, 0
  v_dot2_f32_bf16 v25, v92, v4, 0
  v_dot2_f32_bf16 v18, v65, v5, v18
  v_dot2_f32_bf16 v19, v69, v5, v19
  v_dot2_f32_bf16 v20, v73, v5, v20
  v_dot2_f32_bf16 v21, v77, v5, v21
  v_dot2_f32_bf16 v22, v81, v5, v22
  v_dot2_f32_bf16 v23, v85, v5, v23
  v_dot2_f32_bf16 v24, v89, v5, v24
  v_dot2_f32_bf16 v25, v93, v5, v25
  v_dot2_f32_bf16 v18, v66, v6, v18
  v_dot2_f32_bf16 v19, v70, v6, v19
  v_dot2_f32_bf16 v20, v74, v6, v20
  v_dot2_f32_bf16 v21, v78, v6, v21
  v_dot2_f32_bf16 v22, v82, v6, v22
  v_dot2_f32_bf16 v23, v86, v6, v23
  v_dot2_f32_bf16 v24, v90, v6, v24
  v_dot2_f32_bf16 v25, v94, v6, v25
  v_dot2_f32_bf16 v18, v67, v7, v18
  v_dot2_f32_bf16 v19, v71, v7, v19
  v_dot2_f32_bf16 v20, v75, v7, v20
  v_dot2_f32_bf16 v21, v79, v7, v21
  v_dot2_f32_bf16 v22, v83, v7, v22
  v_dot2_f32_bf16 v23, v87, v7, v23
  v_dot2_f32_bf16 v24, v91, v7, v24
  v_dot2_f32_bf16 v25, v95, v7, v25
  s_add_u32 s46, s36, 917504
  buffer_load_dwordx4 v[64:67], v2, s[16:19], s46 offen offset:0 nt
  buffer_load_dwordx4 v[68:71], v2, s[16:19], s46 offen offset:1024 nt
  buffer_load_dwordx4 v[72:75], v2, s[16:19], s46 offen offset:2048 nt
  buffer_load_dwordx4 v[76:79], v2, s[16:19], s46 offen offset:3072 nt
  buffer_load_dwordx4 v[80:83], v3, s[16:19], s46 offen offset:0 nt
  buffer_load_dwordx4 v[84:87], v3, s[16:19], s46 offen offset:1024 nt
  buffer_load_dwordx4 v[88:91], v3, s[16:19], s46 offen offset:2048 nt
  buffer_load_dwordx4 v[92:95], v3, s[16:19], s46 offen offset:3072 nt
  v_add_f32_dpp v18, v18, v18 row_ror:8 row_mask:0xf bank_mask:0xf
  v_add_f32_dpp v19, v19, v19 row_ror:8 row_mask:0xf bank_mask:0xf
  v_add_f32_dpp v20, v20, v20 row_ror:8 row_mask:0xf bank_mask:0xf
  v_add_f32_dpp v21, v21, v21 row_ror:8 row_mask:0xf bank_mask:0xf
  v_add_f32_dpp v22, v22, v22 row_ror:8 row_mask:0xf bank_mask:0xf
  v_add_f32_dpp v23, v23, v23 row_ror:8 row_mask:0xf bank_mask:0xf
  v_add_f32_dpp v24, v24, v24 row_ror:8 row_mask:0xf bank_mask:0xf
  v_add_f32_dpp v25, v25, v25 row_ror:8 row_mask:0xf bank_mask:0xf
  v_add_f32_dpp v18, v18, v18 row_ror:4 row_mask:0xf bank_mask:0xf
  v_add_f32_dpp v19, v19, v19 row_ror:4 row_mask:0xf bank_mask:0xf
  v_add_f32_dpp v20, v20, v20 row_ror:4 row_mask:0xf bank_mask:0xf
  v_add_f32_dpp v21, v21, v21 row_ror:4 row_mask:0xf bank_mask:0xf
  v_add_f32_dpp v22, v22, v22 row_ror:4 row_mask:0xf bank_mask:0xf
  v_add_f32_dpp v23, v23, v23 row_ror:4 row_mask:0xf bank_mask:0xf
  v_add_f32_dpp v24, v24, v24 row_ror:4 row_mask:0xf bank_mask:0xf
  v_add_f32_dpp v25, v25, v25 row_ror:4 row_mask:0xf bank_mask:0xf
  v_add_f32_dpp v18, v18, v18 row_ror:2 row_mask:0xf bank_mask:0xf
  v_add_f32_dpp v19, v19, v19 row_ror:2 row_mask:0xf bank_mask:0xf
  v_add_f32_dpp v20, v20, v20 row_ror:2 row_mask:0xf bank_mask:0xf
  v_add_f32_dpp v21, v21, v21 row_ror:2 row_mask:0xf bank_mask:0xf
  v_add_f32_dpp v22, v22, v22 row_ror:2 row_mask:0xf bank_mask:0xf
  v_add_f32_dpp v23, v23, v23 row_ror:2 row_mask:0xf bank_mask:0xf
  v_add_f32_dpp v24, v24, v24 row_ror:2 row_mask:0xf bank_mask:0xf
  v_add_f32_dpp v25, v25, v25 row_ror:2 row_mask:0xf bank_mask:0xf
  v_add_f32_dpp v18, v18, v18 row_ror:1 row_mask:0xf bank_mask:0xf
  v_add_f32_dpp v19, v19, v19 row_ror:1 row_mask:0xf bank_mask:0xf
  v_add_f32_dpp v20, v20, v20 row_ror:1 row_mask:0xf bank_mask:0xf
  v_add_f32_dpp v21, v21, v21 row_ror:1 row_mask:0xf bank_mask:0xf
  v_add_f32_dpp v22, v22, v22 row_ror:1 row_mask:0xf bank_mask:0xf
  v_add_f32_dpp v23, v23, v23 row_ror:1 row_mask:0xf bank_mask:0xf
  v_add_f32_dpp v24, v24, v24 row_ror:1 row_mask:0xf bank_mask:0xf
  v_add_f32_dpp v25, v25, v25 row_ror:1 row_mask:0xf bank_mask:0xf
  v_cvt_pk_bf16_f32 v26, v18, v19
  v_cvt_pk_bf16_f32 v27, v20, v21
  v_cvt_pk_bf16_f32 v28, v22, v23
  v_cvt_pk_bf16_f32 v29, v24, v25
  v_lshlrev_b32 v18, 16, v26
  v_and_b32 v19, 0xffff0000, v26
  v_lshlrev_b32 v20, 16, v27
  v_and_b32 v21, 0xffff0000, v27
  v_lshlrev_b32 v22, 16, v28
  v_and_b32 v23, 0xffff0000, v28
  v_lshlrev_b32 v24, 16, v29
  v_and_b32 v25, 0xffff0000, v29
  v_mul_f32 v18, s44, v18
  v_mul_f32 v19, s44, v19
  v_mul_f32 v20, s44, v20
  v_mul_f32 v21, s44, v21
  v_mul_f32 v22, s44, v22
  v_mul_f32 v23, s44, v23
  v_mul_f32 v24, s44, v24
  v_mul_f32 v25, s44, v25
  v_cvt_pk_bf16_f32 v116, v18, v19
  v_max3_f32 v30, v30, v18, v19
  v_cvt_pk_bf16_f32 v117, v20, v21
  v_max3_f32 v30, v30, v20, v21
  v_cvt_pk_bf16_f32 v118, v22, v23
  v_max3_f32 v30, v30, v22, v23
  v_cvt_pk_bf16_f32 v119, v24, v25
  v_max3_f32 v30, v30, v24, v25
  s_waitcnt vmcnt(8)
  v_dot2_f32_bf16 v18, v32, v4, 0
  v_dot2_f32_bf16 v19, v36, v4, 0
  v_dot2_f32_bf16 v20, v40, v4, 0
  v_dot2_f32_bf16 v21, v44, v4, 0
  v_dot2_f32_bf16 v22, v48, v4, 0
  v_dot2_f32_bf16 v23, v52, v4, 0
  v_dot2_f32_bf16 v24, v56, v4, 0
  v_dot2_f32_bf16 v25, v60, v4, 0
  v_dot2_f32_bf16 v18, v33, v5, v18
  v_dot2_f32_bf16 v19, v37, v5, v19
  v_dot2_f32_bf16 v20, v41, v5, v20
  v_dot2_f32_bf16 v21, v45, v5, v21
  v_dot2_f32_bf16 v22, v49, v5, v22
  v_dot2_f32_bf16 v23, v53, v5, v23
  v_dot2_f32_bf16 v24, v57, v5, v24
  v_dot2_f32_bf16 v25, v61, v5, v25
  v_dot2_f32_bf16 v18, v34, v6, v18
  v_dot2_f32_bf16 v19, v38, v6, v19
  v_dot2_f32_bf16 v20, v42, v6, v20
  v_dot2_f32_bf16 v21, v46, v6, v21
  v_dot2_f32_bf16 v22, v50, v6, v22
  v_dot2_f32_bf16 v23, v54, v6, v23
  v_dot2_f32_bf16 v24, v58, v6, v24
  v_dot2_f32_bf16 v25, v62, v6, v25
  v_dot2_f32_bf16 v18, v35, v7, v18
  v_dot2_f32_bf16 v19, v39, v7, v19
  v_dot2_f32_bf16 v20, v43, v7, v20
  v_dot2_f32_bf16 v21, v47, v7, v21
  v_dot2_f32_bf16 v22, v51, v7, v22
  v_dot2_f32_bf16 v23, v55, v7, v23
  v_dot2_f32_bf16 v24, v59, v7, v24
  v_dot2_f32_bf16 v25, v63, v7, v25
  s_add_u32 s46, s36, 0
  buffer_load_dwordx4 v[32:35], v2, s[20:23], s46 offen offset:0 nt
  buffer_load_dwordx4 v[36:39], v2, s[20:23], s46 offen offset:1024 nt
  buffer_load_dwordx4 v[40:43], v2, s[20:23], s46 offen offset:2048 nt
  buffer_load_dwordx4 v[44:47], v2, s[20:23], s46 offen offset:3072 nt
  buffer_load_dwordx4 v[48:51], v3, s[20:23], s46 offen offset:0 nt
  buffer_load_dwordx4 v[52:55], v3, s[20:23], s46 offen offset:1024 nt
  buffer_load_dwordx4 v[56:59], v3, s[20:23], s46 offen offset:2048 nt
  buffer_load_dwordx4 v[60:63], v3, s[20:23], s46 offen offset:3072 nt
  v_add_f32_dpp v18, v18, v18 row_ror:8 row_mask:0xf bank_mask:0xf
  v_add_f32_dpp v19, v19, v19 row_ror:8 row_mask:0xf bank_mask:0xf
  v_add_f32_dpp v20, v20, v20 row_ror:8 row_mask:0xf bank_mask:0xf
  v_add_f32_dpp v21, v21, v21 row_ror:8 row_mask:0xf bank_mask:0xf
  v_add_f32_dpp v22, v22, v22 row_ror:8 row_mask:0xf bank_mask:0xf
  v_add_f32_dpp v23, v23, v23 row_ror:8 row_mask:0xf bank_mask:0xf
  v_add_f32_dpp v24, v24, v24 row_ror:8 row_mask:0xf bank_mask:0xf
  v_add_f32_dpp v25, v25, v25 row_ror:8 row_mask:0xf bank_mask:0xf
  v_add_f32_dpp v18, v18, v18 row_ror:4 row_mask:0xf bank_mask:0xf
  v_add_f32_dpp v19, v19, v19 row_ror:4 row_mask:0xf bank_mask:0xf
  v_add_f32_dpp v20, v20, v20 row_ror:4 row_mask:0xf bank_mask:0xf
  v_add_f32_dpp v21, v21, v21 row_ror:4 row_mask:0xf bank_mask:0xf
  v_add_f32_dpp v22, v22, v22 row_ror:4 row_mask:0xf bank_mask:0xf
  v_add_f32_dpp v23, v23, v23 row_ror:4 row_mask:0xf bank_mask:0xf
  v_add_f32_dpp v24, v24, v24 row_ror:4 row_mask:0xf bank_mask:0xf
  v_add_f32_dpp v25, v25, v25 row_ror:4 row_mask:0xf bank_mask:0xf
  v_add_f32_dpp v18, v18, v18 row_ror:2 row_mask:0xf bank_mask:0xf
  v_add_f32_dpp v19, v19, v19 row_ror:2 row_mask:0xf bank_mask:0xf
  v_add_f32_dpp v20, v20, v20 row_ror:2 row_mask:0xf bank_mask:0xf
  v_add_f32_dpp v21, v21, v21 row_ror:2 row_mask:0xf bank_mask:0xf
  v_add_f32_dpp v22, v22, v22 row_ror:2 row_mask:0xf bank_mask:0xf
  v_add_f32_dpp v23, v23, v23 row_ror:2 row_mask:0xf bank_mask:0xf
  v_add_f32_dpp v24, v24, v24 row_ror:2 row_mask:0xf bank_mask:0xf
  v_add_f32_dpp v25, v25, v25 row_ror:2 row_mask:0xf bank_mask:0xf
  v_add_f32_dpp v18, v18, v18 row_ror:1 row_mask:0xf bank_mask:0xf
  v_add_f32_dpp v19, v19, v19 row_ror:1 row_mask:0xf bank_mask:0xf
  v_add_f32_dpp v20, v20, v20 row_ror:1 row_mask:0xf bank_mask:0xf
  v_add_f32_dpp v21, v21, v21 row_ror:1 row_mask:0xf bank_mask:0xf
  v_add_f32_dpp v22, v22, v22 row_ror:1 row_mask:0xf bank_mask:0xf
  v_add_f32_dpp v23, v23, v23 row_ror:1 row_mask:0xf bank_mask:0xf
  v_add_f32_dpp v24, v24, v24 row_ror:1 row_mask:0xf bank_mask:0xf
  v_add_f32_dpp v25, v25, v25 row_ror:1 row_mask:0xf bank_mask:0xf
  v_cvt_pk_bf16_f32 v26, v18, v19
  v_cvt_pk_bf16_f32 v27, v20, v21
  v_cvt_pk_bf16_f32 v28, v22, v23
  v_cvt_pk_bf16_f32 v29, v24, v25
  v_lshlrev_b32 v18, 16, v26
  v_and_b32 v19, 0xffff0000, v26
  v_lshlrev_b32 v20, 16, v27
  v_and_b32 v21, 0xffff0000, v27
  v_lshlrev_b32 v22, 16, v28
  v_and_b32 v23, 0xffff0000, v28
  v_lshlrev_b32 v24, 16, v29
  v_and_b32 v25, 0xffff0000, v29
  v_mul_f32 v18, s44, v18
  v_mul_f32 v19, s44, v19
  v_mul_f32 v20, s44, v20
  v_mul_f32 v21, s44, v21
  v_mul_f32 v22, s44, v22
  v_mul_f32 v23, s44, v23
  v_mul_f32 v24, s44, v24
  v_mul_f32 v25, s44, v25
  v_cvt_pk_bf16_f32 v120, v18, v19
  v_max3_f32 v30, v30, v18, v19
  v_cvt_pk_bf16_f32 v121, v20, v21
  v_max3_f32 v30, v30, v20, v21
  v_cvt_pk_bf16_f32 v122, v22, v23
  v_max3_f32 v30, v30, v22, v23
  v_cvt_pk_bf16_f32 v123, v24, v25
  v_max3_f32 v30, v30, v24, v25
  s_waitcnt vmcnt(8)
  v_dot2_f32_bf16 v18, v64, v4, 0
  v_dot2_f32_bf16 v19, v68, v4, 0
  v_dot2_f32_bf16 v20, v72, v4, 0
  v_dot2_f32_bf16 v21, v76, v4, 0
  v_dot2_f32_bf16 v22, v80, v4, 0
  v_dot2_f32_bf16 v23, v84, v4, 0
  v_dot2_f32_bf16 v24, v88, v4, 0
  v_dot2_f32_bf16 v25, v92, v4, 0
  v_dot2_f32_bf16 v18, v65, v5, v18
  v_dot2_f32_bf16 v19, v69, v5, v19
  v_dot2_f32_bf16 v20, v73, v5, v20
  v_dot2_f32_bf16 v21, v77, v5, v21
  v_dot2_f32_bf16 v22, v81, v5, v22
  v_dot2_f32_bf16 v23, v85, v5, v23
  v_dot2_f32_bf16 v24, v89, v5, v24
  v_dot2_f32_bf16 v25, v93, v5, v25
  v_dot2_f32_bf16 v18, v66, v6, v18
  v_dot2_f32_bf16 v19, v70, v6, v19
  v_dot2_f32_bf16 v20, v74, v6, v20
  v_dot2_f32_bf16 v21, v78, v6, v21
  v_dot2_f32_bf16 v22, v82, v6, v22
  v_dot2_f32_bf16 v23, v86, v6, v23
  v_dot2_f32_bf16 v24, v90, v6, v24
  v_dot2_f32_bf16 v25, v94, v6, v25
  v_dot2_f32_bf16 v18, v67, v7, v18
  v_dot2_f32_bf16 v19, v71, v7, v19
  v_dot2_f32_bf16 v20, v75, v7, v20
  v_dot2_f32_bf16 v21, v79, v7, v21
  v_dot2_f32_bf16 v22, v83, v7, v22
  v_dot2_f32_bf16 v23, v87, v7, v23
  v_dot2_f32_bf16 v24, v91, v7, v24
  v_dot2_f32_bf16 v25, v95, v7, v25
  s_add_u32 s46, s36, 131072
  buffer_load_dwordx4 v[64:67], v2, s[20:23], s46 offen offset:0 nt
  buffer_load_dwordx4 v[68:71], v2, s[20:23], s46 offen offset:1024 nt
  buffer_load_dwordx4 v[72:75], v2, s[20:23], s46 offen offset:2048 nt
  buffer_load_dwordx4 v[76:79], v2, s[20:23], s46 offen offset:3072 nt
  buffer_load_dwordx4 v[80:83], v3, s[20:23], s46 offen offset:0 nt
  buffer_load_dwordx4 v[84:87], v3, s[20:23], s46 offen offset:1024 nt
  buffer_load_dwordx4 v[88:91], v3, s[20:23], s46 offen offset:2048 nt
  buffer_load_dwordx4 v[92:95], v3, s[20:23], s46 offen offset:3072 nt
  v_add_f32_dpp v18, v18, v18 row_ror:8 row_mask:0xf bank_mask:0xf
  v_add_f32_dpp v19, v19, v19 row_ror:8 row_mask:0xf bank_mask:0xf
  v_add_f32_dpp v20, v20, v20 row_ror:8 row_mask:0xf bank_mask:0xf
  v_add_f32_dpp v21, v21, v21 row_ror:8 row_mask:0xf bank_mask:0xf
  v_add_f32_dpp v22, v22, v22 row_ror:8 row_mask:0xf bank_mask:0xf
  v_add_f32_dpp v23, v23, v23 row_ror:8 row_mask:0xf bank_mask:0xf
  v_add_f32_dpp v24, v24, v24 row_ror:8 row_mask:0xf bank_mask:0xf
  v_add_f32_dpp v25, v25, v25 row_ror:8 row_mask:0xf bank_mask:0xf
  v_add_f32_dpp v18, v18, v18 row_ror:4 row_mask:0xf bank_mask:0xf
  v_add_f32_dpp v19, v19, v19 row_ror:4 row_mask:0xf bank_mask:0xf
  v_add_f32_dpp v20, v20, v20 row_ror:4 row_mask:0xf bank_mask:0xf
  v_add_f32_dpp v21, v21, v21 row_ror:4 row_mask:0xf bank_mask:0xf
  v_add_f32_dpp v22, v22, v22 row_ror:4 row_mask:0xf bank_mask:0xf
  v_add_f32_dpp v23, v23, v23 row_ror:4 row_mask:0xf bank_mask:0xf
  v_add_f32_dpp v24, v24, v24 row_ror:4 row_mask:0xf bank_mask:0xf
  v_add_f32_dpp v25, v25, v25 row_ror:4 row_mask:0xf bank_mask:0xf
  v_add_f32_dpp v18, v18, v18 row_ror:2 row_mask:0xf bank_mask:0xf
  v_add_f32_dpp v19, v19, v19 row_ror:2 row_mask:0xf bank_mask:0xf
  v_add_f32_dpp v20, v20, v20 row_ror:2 row_mask:0xf bank_mask:0xf
  v_add_f32_dpp v21, v21, v21 row_ror:2 row_mask:0xf bank_mask:0xf
  v_add_f32_dpp v22, v22, v22 row_ror:2 row_mask:0xf bank_mask:0xf
  v_add_f32_dpp v23, v23, v23 row_ror:2 row_mask:0xf bank_mask:0xf
  v_add_f32_dpp v24, v24, v24 row_ror:2 row_mask:0xf bank_mask:0xf
  v_add_f32_dpp v25, v25, v25 row_ror:2 row_mask:0xf bank_mask:0xf
  v_add_f32_dpp v18, v18, v18 row_ror:1 row_mask:0xf bank_mask:0xf
  v_add_f32_dpp v19, v19, v19 row_ror:1 row_mask:0xf bank_mask:0xf
  v_add_f32_dpp v20, v20, v20 row_ror:1 row_mask:0xf bank_mask:0xf
  v_add_f32_dpp v21, v21, v21 row_ror:1 row_mask:0xf bank_mask:0xf
  v_add_f32_dpp v22, v22, v22 row_ror:1 row_mask:0xf bank_mask:0xf
  v_add_f32_dpp v23, v23, v23 row_ror:1 row_mask:0xf bank_mask:0xf
  v_add_f32_dpp v24, v24, v24 row_ror:1 row_mask:0xf bank_mask:0xf
  v_add_f32_dpp v25, v25, v25 row_ror:1 row_mask:0xf bank_mask:0xf
  v_cvt_pk_bf16_f32 v26, v18, v19
  v_cvt_pk_bf16_f32 v27, v20, v21
  v_cvt_pk_bf16_f32 v28, v22, v23
  v_cvt_pk_bf16_f32 v29, v24, v25
  v_lshlrev_b32 v18, 16, v26
  v_and_b32 v19, 0xffff0000, v26
  v_lshlrev_b32 v20, 16, v27
  v_and_b32 v21, 0xffff0000, v27
  v_lshlrev_b32 v22, 16, v28
  v_and_b32 v23, 0xffff0000, v28
  v_lshlrev_b32 v24, 16, v29
  v_and_b32 v25, 0xffff0000, v29
  v_mul_f32 v18, s44, v18
  v_mul_f32 v19, s44, v19
  v_mul_f32 v20, s44, v20
  v_mul_f32 v21, s44, v21
  v_mul_f32 v22, s44, v22
  v_mul_f32 v23, s44, v23
  v_mul_f32 v24, s44, v24
  v_mul_f32 v25, s44, v25
  v_cvt_pk_bf16_f32 v124, v18, v19
  v_max3_f32 v30, v30, v18, v19
  v_cvt_pk_bf16_f32 v125, v20, v21
  v_max3_f32 v30, v30, v20, v21
  v_cvt_pk_bf16_f32 v126, v22, v23
  v_max3_f32 v30, v30, v22, v23
  v_cvt_pk_bf16_f32 v127, v24, v25
  v_max3_f32 v30, v30, v24, v25
  v_cvt_pk_bf16_f32 v30, v30, v30
  v_lshlrev_b32 v30, 16, v30
  v_mov_b32 v16, v30
  s_waitcnt vmcnt(8)
  v_lshlrev_b32 v18, 16, v96
  v_and_b32 v19, 0xffff0000, v96
  v_lshlrev_b32 v20, 16, v97
  v_and_b32 v21, 0xffff0000, v97
  v_lshlrev_b32 v22, 16, v98
  v_and_b32 v23, 0xffff0000, v98
  v_lshlrev_b32 v24, 16, v99
  v_and_b32 v25, 0xffff0000, v99
  v_sub_f32 v18, v18, v16
  v_sub_f32 v19, v19, v16
  v_sub_f32 v20, v20, v16
  v_sub_f32 v21, v21, v16
  v_sub_f32 v22, v22, v16
  v_sub_f32 v23, v23, v16
  v_sub_f32 v24, v24, v16
  v_sub_f32 v25, v25, v16
  v_mul_f32 v18, s45, v18
  v_mul_f32 v19, s45, v19
  v_mul_f32 v20, s45, v20
  v_mul_f32 v21, s45, v21
  v_mul_f32 v22, s45, v22
  v_mul_f32 v23, s45, v23
  v_mul_f32 v24, s45, v24
  v_mul_f32 v25, s45, v25
  v_exp_f32 v18, v18
  v_exp_f32 v19, v19
  v_exp_f32 v20, v20
  v_exp_f32 v21, v21
  v_exp_f32 v22, v22
  v_exp_f32 v23, v23
  v_exp_f32 v24, v24
  v_exp_f32 v25, v25
  v_add_f32 v26, v18, v19
  v_add_f32 v27, v20, v21
  v_add_f32 v28, v22, v23
  v_add_f32 v29, v24, v25
  v_add_f32 v26, v26, v27
  v_add_f32 v28, v28, v29
  v_add_f32 v26, v26, v28
  v_add_f32 v17, v17, v26
  v_cvt_pk_bf16_f32 v26, v18, 0
  v_cvt_pk_bf16_f32 v27, 0, v18
  v_dot2_f32_bf16 v8, v32, v26, v8
  v_dot2_f32_bf16 v9, v32, v27, v9
  v_dot2_f32_bf16 v10, v33, v26, v10
  v_dot2_f32_bf16 v11, v33, v27, v11
  v_dot2_f32_bf16 v12, v34, v26, v12
  v_dot2_f32_bf16 v13, v34, v27, v13
  v_dot2_f32_bf16 v14, v35, v26, v14
  v_dot2_f32_bf16 v15, v35, v27, v15
  v_cvt_pk_bf16_f32 v28, v19, 0
  v_cvt_pk_bf16_f32 v29, 0, v19
  v_dot2_f32_bf16 v8, v36, v28, v8
  v_dot2_f32_bf16 v9, v36, v29, v9
  v_dot2_f32_bf16 v10, v37, v28, v10
  v_dot2_f32_bf16 v11, v37, v29, v11
  v_dot2_f32_bf16 v12, v38, v28, v12
  v_dot2_f32_bf16 v13, v38, v29, v13
  v_dot2_f32_bf16 v14, v39, v28, v14
  v_dot2_f32_bf16 v15, v39, v29, v15
  v_cvt_pk_bf16_f32 v26, v20, 0
  v_cvt_pk_bf16_f32 v27, 0, v20
  v_dot2_f32_bf16 v8, v40, v26, v8
  v_dot2_f32_bf16 v9, v40, v27, v9
  v_dot2_f32_bf16 v10, v41, v26, v10
  v_dot2_f32_bf16 v11, v41, v27, v11
  v_dot2_f32_bf16 v12, v42, v26, v12
  v_dot2_f32_bf16 v13, v42, v27, v13
  v_dot2_f32_bf16 v14, v43, v26, v14
  v_dot2_f32_bf16 v15, v43, v27, v15
  v_cvt_pk_bf16_f32 v28, v21, 0
  v_cvt_pk_bf16_f32 v29, 0, v21
  v_dot2_f32_bf16 v8, v44, v28, v8
  v_dot2_f32_bf16 v9, v44, v29, v9
  v_dot2_f32_bf16 v10, v45, v28, v10
  v_dot2_f32_bf16 v11, v45, v29, v11
  v_dot2_f32_bf16 v12, v46, v28, v12
  v_dot2_f32_bf16 v13, v46, v29, v13
  v_dot2_f32_bf16 v14, v47, v28, v14
  v_dot2_f32_bf16 v15, v47, v29, v15
  v_cvt_pk_bf16_f32 v26, v22, 0
  v_cvt_pk_bf16_f32 v27, 0, v22
  v_dot2_f32_bf16 v8, v48, v26, v8
  v_dot2_f32_bf16 v9, v48, v27, v9
  v_dot2_f32_bf16 v10, v49, v26, v10
  v_dot2_f32_bf16 v11, v49, v27, v11
  v_dot2_f32_bf16 v12, v50, v26, v12
  v_dot2_f32_bf16 v13, v50, v27, v13
  v_dot2_f32_bf16 v14, v51, v26, v14
  v_dot2_f32_bf16 v15, v51, v27, v15
  v_cvt_pk_bf16_f32 v28, v23, 0
  v_cvt_pk_bf16_f32 v29, 0, v23
  v_dot2_f32_bf16 v8, v52, v28, v8
  v_dot2_f32_bf16 v9, v52, v29, v9
  v_dot2_f32_bf16 v10, v53, v28, v10
  v_dot2_f32_bf16 v11, v53, v29, v11
  v_dot2_f32_bf16 v12, v54, v28, v12
  v_dot2_f32_bf16 v13, v54, v29, v13
  v_dot2_f32_bf16 v14, v55, v28, v14
  v_dot2_f32_bf16 v15, v55, v29, v15
  v_cvt_pk_bf16_f32 v26, v24, 0
  v_cvt_pk_bf16_f32 v27, 0, v24
  v_dot2_f32_bf16 v8, v56, v26, v8
  v_dot2_f32_bf16 v9, v56, v27, v9
  v_dot2_f32_bf16 v10, v57, v26, v10
  v_dot2_f32_bf16 v11, v57, v27, v11
  v_dot2_f32_bf16 v12, v58, v26, v12
  v_dot2_f32_bf16 v13, v58, v27, v13
  v_dot2_f32_bf16 v14, v59, v26, v14
  v_dot2_f32_bf16 v15, v59, v27, v15
  v_cvt_pk_bf16_f32 v28, v25, 0
  v_cvt_pk_bf16_f32 v29, 0, v25
  v_dot2_f32_bf16 v8, v60, v28, v8
  v_dot2_f32_bf16 v9, v60, v29, v9
  v_dot2_f32_bf16 v10, v61, v28, v10
  v_dot2_f32_bf16 v11, v61, v29, v11
  v_dot2_f32_bf16 v12, v62, v28, v12
  v_dot2_f32_bf16 v13, v62, v29, v13
  v_dot2_f32_bf16 v14, v63, v28, v14
  v_dot2_f32_bf16 v15, v63, v29, v15
  s_add_u32 s46, s36, 262144
  buffer_load_dwordx4 v[32:35], v2, s[20:23], s46 offen offset:0 nt
  buffer_load_dwordx4 v[36:39], v2, s[20:23], s46 offen offset:1024 nt
  buffer_load_dwordx4 v[40:43], v2, s[20:23], s46 offen offset:2048 nt
  buffer_load_dwordx4 v[44:47], v2, s[20:23], s46 offen offset:3072 nt
  buffer_load_dwordx4 v[48:51], v3, s[20:23], s46 offen offset:0 nt
  buffer_load_dwordx4 v[52:55], v3, s[20:23], s46 offen offset:1024 nt
  buffer_load_dwordx4 v[56:59], v3, s[20:23], s46 offen offset:2048 nt
  buffer_load_dwordx4 v[60:63], v3, s[20:23], s46 offen offset:3072 nt
  s_waitcnt vmcnt(8)
  v_lshlrev_b32 v18, 16, v100
  v_and_b32 v19, 0xffff0000, v100
  v_lshlrev_b32 v20, 16, v101
  v_and_b32 v21, 0xffff0000, v101
  v_lshlrev_b32 v22, 16, v102
  v_and_b32 v23, 0xffff0000, v102
  v_lshlrev_b32 v24, 16, v103
  v_and_b32 v25, 0xffff0000, v103
  v_sub_f32 v18, v18, v16
  v_sub_f32 v19, v19, v16
  v_sub_f32 v20, v20, v16
  v_sub_f32 v21, v21, v16
  v_sub_f32 v22, v22, v16
  v_sub_f32 v23, v23, v16
  v_sub_f32 v24, v24, v16
  v_sub_f32 v25, v25, v16
  v_mul_f32 v18, s45, v18
  v_mul_f32 v19, s45, v19
  v_mul_f32 v20, s45, v20
  v_mul_f32 v21, s45, v21
  v_mul_f32 v22, s45, v22
  v_mul_f32 v23, s45, v23
  v_mul_f32 v24, s45, v24
  v_mul_f32 v25, s45, v25
  v_exp_f32 v18, v18
  v_exp_f32 v19, v19
  v_exp_f32 v20, v20
  v_exp_f32 v21, v21
  v_exp_f32 v22, v22
  v_exp_f32 v23, v23
  v_exp_f32 v24, v24
  v_exp_f32 v25, v25
  v_add_f32 v26, v18, v19
  v_add_f32 v27, v20, v21
  v_add_f32 v28, v22, v23
  v_add_f32 v29, v24, v25
  v_add_f32 v26, v26, v27
  v_add_f32 v28, v28, v29
  v_add_f32 v26, v26, v28
  v_add_f32 v17, v17, v26
  v_cvt_pk_bf16_f32 v26, v18, 0
  v_cvt_pk_bf16_f32 v27, 0, v18
  v_dot2_f32_bf16 v8, v64, v26, v8
  v_dot2_f32_bf16 v9, v64, v27, v9
  v_dot2_f32_bf16 v10, v65, v26, v10
  v_dot2_f32_bf16 v11, v65, v27, v11
  v_dot2_f32_bf16 v12, v66, v26, v12
  v_dot2_f32_bf16 v13, v66, v27, v13
  v_dot2_f32_bf16 v14, v67, v26, v14
  v_dot2_f32_bf16 v15, v67, v27, v15
  v_cvt_pk_bf16_f32 v28, v19, 0
  v_cvt_pk_bf16_f32 v29, 0, v19
  v_dot2_f32_bf16 v8, v68, v28, v8
  v_dot2_f32_bf16 v9, v68, v29, v9
  v_dot2_f32_bf16 v10, v69, v28, v10
  v_dot2_f32_bf16 v11, v69, v29, v11
  v_dot2_f32_bf16 v12, v70, v28, v12
  v_dot2_f32_bf16 v13, v70, v29, v13
  v_dot2_f32_bf16 v14, v71, v28, v14
  v_dot2_f32_bf16 v15, v71, v29, v15
  v_cvt_pk_bf16_f32 v26, v20, 0
  v_cvt_pk_bf16_f32 v27, 0, v20
  v_dot2_f32_bf16 v8, v72, v26, v8
  v_dot2_f32_bf16 v9, v72, v27, v9
  v_dot2_f32_bf16 v10, v73, v26, v10
  v_dot2_f32_bf16 v11, v73, v27, v11
  v_dot2_f32_bf16 v12, v74, v26, v12
  v_dot2_f32_bf16 v13, v74, v27, v13
  v_dot2_f32_bf16 v14, v75, v26, v14
  v_dot2_f32_bf16 v15, v75, v27, v15
  v_cvt_pk_bf16_f32 v28, v21, 0
  v_cvt_pk_bf16_f32 v29, 0, v21
  v_dot2_f32_bf16 v8, v76, v28, v8
  v_dot2_f32_bf16 v9, v76, v29, v9
  v_dot2_f32_bf16 v10, v77, v28, v10
  v_dot2_f32_bf16 v11, v77, v29, v11
  v_dot2_f32_bf16 v12, v78, v28, v12
  v_dot2_f32_bf16 v13, v78, v29, v13
  v_dot2_f32_bf16 v14, v79, v28, v14
  v_dot2_f32_bf16 v15, v79, v29, v15
  v_cvt_pk_bf16_f32 v26, v22, 0
  v_cvt_pk_bf16_f32 v27, 0, v22
  v_dot2_f32_bf16 v8, v80, v26, v8
  v_dot2_f32_bf16 v9, v80, v27, v9
  v_dot2_f32_bf16 v10, v81, v26, v10
  v_dot2_f32_bf16 v11, v81, v27, v11
  v_dot2_f32_bf16 v12, v82, v26, v12
  v_dot2_f32_bf16 v13, v82, v27, v13
  v_dot2_f32_bf16 v14, v83, v26, v14
  v_dot2_f32_bf16 v15, v83, v27, v15
  v_cvt_pk_bf16_f32 v28, v23, 0
  v_cvt_pk_bf16_f32 v29, 0, v23
  v_dot2_f32_bf16 v8, v84, v28, v8
  v_dot2_f32_bf16 v9, v84, v29, v9
  v_dot2_f32_bf16 v10, v85, v28, v10
  v_dot2_f32_bf16 v11, v85, v29, v11
  v_dot2_f32_bf16 v12, v86, v28, v12
  v_dot2_f32_bf16 v13, v86, v29, v13
  v_dot2_f32_bf16 v14, v87, v28, v14
  v_dot2_f32_bf16 v15, v87, v29, v15
  v_cvt_pk_bf16_f32 v26, v24, 0
  v_cvt_pk_bf16_f32 v27, 0, v24
  v_dot2_f32_bf16 v8, v88, v26, v8
  v_dot2_f32_bf16 v9, v88, v27, v9
  v_dot2_f32_bf16 v10, v89, v26, v10
  v_dot2_f32_bf16 v11, v89, v27, v11
  v_dot2_f32_bf16 v12, v90, v26, v12
  v_dot2_f32_bf16 v13, v90, v27, v13
  v_dot2_f32_bf16 v14, v91, v26, v14
  v_dot2_f32_bf16 v15, v91, v27, v15
  v_cvt_pk_bf16_f32 v28, v25, 0
  v_cvt_pk_bf16_f32 v29, 0, v25
  v_dot2_f32_bf16 v8, v92, v28, v8
  v_dot2_f32_bf16 v9, v92, v29, v9
  v_dot2_f32_bf16 v10, v93, v28, v10
  v_dot2_f32_bf16 v11, v93, v29, v11
  v_dot2_f32_bf16 v12, v94, v28, v12
  v_dot2_f32_bf16 v13, v94, v29, v13
  v_dot2_f32_bf16 v14, v95, v28, v14
  v_dot2_f32_bf16 v15, v95, v29, v15
  s_add_u32 s46, s36, 393216
  buffer_load_dwordx4 v[64:67], v2, s[20:23], s46 offen offset:0 nt
  buffer_load_dwordx4 v[68:71], v2, s[20:23], s46 offen offset:1024 nt
  buffer_load_dwordx4 v[72:75], v2, s[20:23], s46 offen offset:2048 nt
  buffer_load_dwordx4 v[76:79], v2, s[20:23], s46 offen offset:3072 nt
  buffer_load_dwordx4 v[80:83], v3, s[20:23], s46 offen offset:0 nt
  buffer_load_dwordx4 v[84:87], v3, s[20:23], s46 offen offset:1024 nt
  buffer_load_dwordx4 v[88:91], v3, s[20:23], s46 offen offset:2048 nt
  buffer_load_dwordx4 v[92:95], v3, s[20:23], s46 offen offset:3072 nt
  s_waitcnt vmcnt(8)
  v_lshlrev_b32 v18, 16, v104
  v_and_b32 v19, 0xffff0000, v104
  v_lshlrev_b32 v20, 16, v105
  v_and_b32 v21, 0xffff0000, v105
  v_lshlrev_b32 v22, 16, v106
  v_and_b32 v23, 0xffff0000, v106
  v_lshlrev_b32 v24, 16, v107
  v_and_b32 v25, 0xffff0000, v107
  v_sub_f32 v18, v18, v16
  v_sub_f32 v19, v19, v16
  v_sub_f32 v20, v20, v16
  v_sub_f32 v21, v21, v16
  v_sub_f32 v22, v22, v16
  v_sub_f32 v23, v23, v16
  v_sub_f32 v24, v24, v16
  v_sub_f32 v25, v25, v16
  v_mul_f32 v18, s45, v18
  v_mul_f32 v19, s45, v19
  v_mul_f32 v20, s45, v20
  v_mul_f32 v21, s45, v21
  v_mul_f32 v22, s45, v22
  v_mul_f32 v23, s45, v23
  v_mul_f32 v24, s45, v24
  v_mul_f32 v25, s45, v25
  v_exp_f32 v18, v18
  v_exp_f32 v19, v19
  v_exp_f32 v20, v20
  v_exp_f32 v21, v21
  v_exp_f32 v22, v22
  v_exp_f32 v23, v23
  v_exp_f32 v24, v24
  v_exp_f32 v25, v25
  v_add_f32 v26, v18, v19
  v_add_f32 v27, v20, v21
  v_add_f32 v28, v22, v23
  v_add_f32 v29, v24, v25
  v_add_f32 v26, v26, v27
  v_add_f32 v28, v28, v29
  v_add_f32 v26, v26, v28
  v_add_f32 v17, v17, v26
  v_cvt_pk_bf16_f32 v26, v18, 0
  v_cvt_pk_bf16_f32 v27, 0, v18
  v_dot2_f32_bf16 v8, v32, v26, v8
  v_dot2_f32_bf16 v9, v32, v27, v9
  v_dot2_f32_bf16 v10, v33, v26, v10
  v_dot2_f32_bf16 v11, v33, v27, v11
  v_dot2_f32_bf16 v12, v34, v26, v12
  v_dot2_f32_bf16 v13, v34, v27, v13
  v_dot2_f32_bf16 v14, v35, v26, v14
  v_dot2_f32_bf16 v15, v35, v27, v15
  v_cvt_pk_bf16_f32 v28, v19, 0
  v_cvt_pk_bf16_f32 v29, 0, v19
  v_dot2_f32_bf16 v8, v36, v28, v8
  v_dot2_f32_bf16 v9, v36, v29, v9
  v_dot2_f32_bf16 v10, v37, v28, v10
  v_dot2_f32_bf16 v11, v37, v29, v11
  v_dot2_f32_bf16 v12, v38, v28, v12
  v_dot2_f32_bf16 v13, v38, v29, v13
  v_dot2_f32_bf16 v14, v39, v28, v14
  v_dot2_f32_bf16 v15, v39, v29, v15
  v_cvt_pk_bf16_f32 v26, v20, 0
  v_cvt_pk_bf16_f32 v27, 0, v20
  v_dot2_f32_bf16 v8, v40, v26, v8
  v_dot2_f32_bf16 v9, v40, v27, v9
  v_dot2_f32_bf16 v10, v41, v26, v10
  v_dot2_f32_bf16 v11, v41, v27, v11
  v_dot2_f32_bf16 v12, v42, v26, v12
  v_dot2_f32_bf16 v13, v42, v27, v13
  v_dot2_f32_bf16 v14, v43, v26, v14
  v_dot2_f32_bf16 v15, v43, v27, v15
  v_cvt_pk_bf16_f32 v28, v21, 0
  v_cvt_pk_bf16_f32 v29, 0, v21
  v_dot2_f32_bf16 v8, v44, v28, v8
  v_dot2_f32_bf16 v9, v44, v29, v9
  v_dot2_f32_bf16 v10, v45, v28, v10
  v_dot2_f32_bf16 v11, v45, v29, v11
  v_dot2_f32_bf16 v12, v46, v28, v12
  v_dot2_f32_bf16 v13, v46, v29, v13
  v_dot2_f32_bf16 v14, v47, v28, v14
  v_dot2_f32_bf16 v15, v47, v29, v15
  v_cvt_pk_bf16_f32 v26, v22, 0
  v_cvt_pk_bf16_f32 v27, 0, v22
  v_dot2_f32_bf16 v8, v48, v26, v8
  v_dot2_f32_bf16 v9, v48, v27, v9
  v_dot2_f32_bf16 v10, v49, v26, v10
  v_dot2_f32_bf16 v11, v49, v27, v11
  v_dot2_f32_bf16 v12, v50, v26, v12
  v_dot2_f32_bf16 v13, v50, v27, v13
  v_dot2_f32_bf16 v14, v51, v26, v14
  v_dot2_f32_bf16 v15, v51, v27, v15
  v_cvt_pk_bf16_f32 v28, v23, 0
  v_cvt_pk_bf16_f32 v29, 0, v23
  v_dot2_f32_bf16 v8, v52, v28, v8
  v_dot2_f32_bf16 v9, v52, v29, v9
  v_dot2_f32_bf16 v10, v53, v28, v10
  v_dot2_f32_bf16 v11, v53, v29, v11
  v_dot2_f32_bf16 v12, v54, v28, v12
  v_dot2_f32_bf16 v13, v54, v29, v13
  v_dot2_f32_bf16 v14, v55, v28, v14
  v_dot2_f32_bf16 v15, v55, v29, v15
  v_cvt_pk_bf16_f32 v26, v24, 0
  v_cvt_pk_bf16_f32 v27, 0, v24
  v_dot2_f32_bf16 v8, v56, v26, v8
  v_dot2_f32_bf16 v9, v56, v27, v9
  v_dot2_f32_bf16 v10, v57, v26, v10
  v_dot2_f32_bf16 v11, v57, v27, v11
  v_dot2_f32_bf16 v12, v58, v26, v12
  v_dot2_f32_bf16 v13, v58, v27, v13
  v_dot2_f32_bf16 v14, v59, v26, v14
  v_dot2_f32_bf16 v15, v59, v27, v15
  v_cvt_pk_bf16_f32 v28, v25, 0
  v_cvt_pk_bf16_f32 v29, 0, v25
  v_dot2_f32_bf16 v8, v60, v28, v8
  v_dot2_f32_bf16 v9, v60, v29, v9
  v_dot2_f32_bf16 v10, v61, v28, v10
  v_dot2_f32_bf16 v11, v61, v29, v11
  v_dot2_f32_bf16 v12, v62, v28, v12
  v_dot2_f32_bf16 v13, v62, v29, v13
  v_dot2_f32_bf16 v14, v63, v28, v14
  v_dot2_f32_bf16 v15, v63, v29, v15
  s_add_u32 s46, s36, 524288
  buffer_load_dwordx4 v[32:35], v2, s[20:23], s46 offen offset:0 nt
  buffer_load_dwordx4 v[36:39], v2, s[20:23], s46 offen offset:1024 nt
  buffer_load_dwordx4 v[40:43], v2, s[20:23], s46 offen offset:2048 nt
  buffer_load_dwordx4 v[44:47], v2, s[20:23], s46 offen offset:3072 nt
  buffer_load_dwordx4 v[48:51], v3, s[20:23], s46 offen offset:0 nt
  buffer_load_dwordx4 v[52:55], v3, s[20:23], s46 offen offset:1024 nt
  buffer_load_dwordx4 v[56:59], v3, s[20:23], s46 offen offset:2048 nt
  buffer_load_dwordx4 v[60:63], v3, s[20:23], s46 offen offset:3072 nt
  s_waitcnt vmcnt(8)
  v_lshlrev_b32 v18, 16, v108
  v_and_b32 v19, 0xffff0000, v108
  v_lshlrev_b32 v20, 16, v109
  v_and_b32 v21, 0xffff0000, v109
  v_lshlrev_b32 v22, 16, v110
  v_and_b32 v23, 0xffff0000, v110
  v_lshlrev_b32 v24, 16, v111
  v_and_b32 v25, 0xffff0000, v111
  v_sub_f32 v18, v18, v16
  v_sub_f32 v19, v19, v16
  v_sub_f32 v20, v20, v16
  v_sub_f32 v21, v21, v16
  v_sub_f32 v22, v22, v16
  v_sub_f32 v23, v23, v16
  v_sub_f32 v24, v24, v16
  v_sub_f32 v25, v25, v16
  v_mul_f32 v18, s45, v18
  v_mul_f32 v19, s45, v19
  v_mul_f32 v20, s45, v20
  v_mul_f32 v21, s45, v21
  v_mul_f32 v22, s45, v22
  v_mul_f32 v23, s45, v23
  v_mul_f32 v24, s45, v24
  v_mul_f32 v25, s45, v25
  v_exp_f32 v18, v18
  v_exp_f32 v19, v19
  v_exp_f32 v20, v20
  v_exp_f32 v21, v21
  v_exp_f32 v22, v22
  v_exp_f32 v23, v23
  v_exp_f32 v24, v24
  v_exp_f32 v25, v25
  v_add_f32 v26, v18, v19
  v_add_f32 v27, v20, v21
  v_add_f32 v28, v22, v23
  v_add_f32 v29, v24, v25
  v_add_f32 v26, v26, v27
  v_add_f32 v28, v28, v29
  v_add_f32 v26, v26, v28
  v_add_f32 v17, v17, v26
  v_cvt_pk_bf16_f32 v26, v18, 0
  v_cvt_pk_bf16_f32 v27, 0, v18
  v_dot2_f32_bf16 v8, v64, v26, v8
  v_dot2_f32_bf16 v9, v64, v27, v9
  v_dot2_f32_bf16 v10, v65, v26, v10
  v_dot2_f32_bf16 v11, v65, v27, v11
  v_dot2_f32_bf16 v12, v66, v26, v12
  v_dot2_f32_bf16 v13, v66, v27, v13
  v_dot2_f32_bf16 v14, v67, v26, v14
  v_dot2_f32_bf16 v15, v67, v27, v15
  v_cvt_pk_bf16_f32 v28, v19, 0
  v_cvt_pk_bf16_f32 v29, 0, v19
  v_dot2_f32_bf16 v8, v68, v28, v8
  v_dot2_f32_bf16 v9, v68, v29, v9
  v_dot2_f32_bf16 v10, v69, v28, v10
  v_dot2_f32_bf16 v11, v69, v29, v11
  v_dot2_f32_bf16 v12, v70, v28, v12
  v_dot2_f32_bf16 v13, v70, v29, v13
  v_dot2_f32_bf16 v14, v71, v28, v14
  v_dot2_f32_bf16 v15, v71, v29, v15
  v_cvt_pk_bf16_f32 v26, v20, 0
  v_cvt_pk_bf16_f32 v27, 0, v20
  v_dot2_f32_bf16 v8, v72, v26, v8
  v_dot2_f32_bf16 v9, v72, v27, v9
  v_dot2_f32_bf16 v10, v73, v26, v10
  v_dot2_f32_bf16 v11, v73, v27, v11
  v_dot2_f32_bf16 v12, v74, v26, v12
  v_dot2_f32_bf16 v13, v74, v27, v13
  v_dot2_f32_bf16 v14, v75, v26, v14
  v_dot2_f32_bf16 v15, v75, v27, v15
  v_cvt_pk_bf16_f32 v28, v21, 0
  v_cvt_pk_bf16_f32 v29, 0, v21
  v_dot2_f32_bf16 v8, v76, v28, v8
  v_dot2_f32_bf16 v9, v76, v29, v9
  v_dot2_f32_bf16 v10, v77, v28, v10
  v_dot2_f32_bf16 v11, v77, v29, v11
  v_dot2_f32_bf16 v12, v78, v28, v12
  v_dot2_f32_bf16 v13, v78, v29, v13
  v_dot2_f32_bf16 v14, v79, v28, v14
  v_dot2_f32_bf16 v15, v79, v29, v15
  v_cvt_pk_bf16_f32 v26, v22, 0
  v_cvt_pk_bf16_f32 v27, 0, v22
  v_dot2_f32_bf16 v8, v80, v26, v8
  v_dot2_f32_bf16 v9, v80, v27, v9
  v_dot2_f32_bf16 v10, v81, v26, v10
  v_dot2_f32_bf16 v11, v81, v27, v11
  v_dot2_f32_bf16 v12, v82, v26, v12
  v_dot2_f32_bf16 v13, v82, v27, v13
  v_dot2_f32_bf16 v14, v83, v26, v14
  v_dot2_f32_bf16 v15, v83, v27, v15
  v_cvt_pk_bf16_f32 v28, v23, 0
  v_cvt_pk_bf16_f32 v29, 0, v23
  v_dot2_f32_bf16 v8, v84, v28, v8
  v_dot2_f32_bf16 v9, v84, v29, v9
  v_dot2_f32_bf16 v10, v85, v28, v10
  v_dot2_f32_bf16 v11, v85, v29, v11
  v_dot2_f32_bf16 v12, v86, v28, v12
  v_dot2_f32_bf16 v13, v86, v29, v13
  v_dot2_f32_bf16 v14, v87, v28, v14
  v_dot2_f32_bf16 v15, v87, v29, v15
  v_cvt_pk_bf16_f32 v26, v24, 0
  v_cvt_pk_bf16_f32 v27, 0, v24
  v_dot2_f32_bf16 v8, v88, v26, v8
  v_dot2_f32_bf16 v9, v88, v27, v9
  v_dot2_f32_bf16 v10, v89, v26, v10
  v_dot2_f32_bf16 v11, v89, v27, v11
  v_dot2_f32_bf16 v12, v90, v26, v12
  v_dot2_f32_bf16 v13, v90, v27, v13
  v_dot2_f32_bf16 v14, v91, v26, v14
  v_dot2_f32_bf16 v15, v91, v27, v15
  v_cvt_pk_bf16_f32 v28, v25, 0
  v_cvt_pk_bf16_f32 v29, 0, v25
  v_dot2_f32_bf16 v8, v92, v28, v8
  v_dot2_f32_bf16 v9, v92, v29, v9
  v_dot2_f32_bf16 v10, v93, v28, v10
  v_dot2_f32_bf16 v11, v93, v29, v11
  v_dot2_f32_bf16 v12, v94, v28, v12
  v_dot2_f32_bf16 v13, v94, v29, v13
  v_dot2_f32_bf16 v14, v95, v28, v14
  v_dot2_f32_bf16 v15, v95, v29, v15
  s_add_u32 s46, s36, 655360
  buffer_load_dwordx4 v[64:67], v2, s[20:23], s46 offen offset:0 nt
  buffer_load_dwordx4 v[68:71], v2, s[20:23], s46 offen offset:1024 nt
  buffer_load_dwordx4 v[72:75], v2, s[20:23], s46 offen offset:2048 nt
  buffer_load_dwordx4 v[76:79], v2, s[20:23], s46 offen offset:3072 nt
  buffer_load_dwordx4 v[80:83], v3, s[20:23], s46 offen offset:0 nt
  buffer_load_dwordx4 v[84:87], v3, s[20:23], s46 offen offset:1024 nt
  buffer_load_dwordx4 v[88:91], v3, s[20:23], s46 offen offset:2048 nt
  buffer_load_dwordx4 v[92:95], v3, s[20:23], s46 offen offset:3072 nt
  s_waitcnt vmcnt(8)
  v_lshlrev_b32 v18, 16, v112
  v_and_b32 v19, 0xffff0000, v112
  v_lshlrev_b32 v20, 16, v113
  v_and_b32 v21, 0xffff0000, v113
  v_lshlrev_b32 v22, 16, v114
  v_and_b32 v23, 0xffff0000, v114
  v_lshlrev_b32 v24, 16, v115
  v_and_b32 v25, 0xffff0000, v115
  v_sub_f32 v18, v18, v16
  v_sub_f32 v19, v19, v16
  v_sub_f32 v20, v20, v16
  v_sub_f32 v21, v21, v16
  v_sub_f32 v22, v22, v16
  v_sub_f32 v23, v23, v16
  v_sub_f32 v24, v24, v16
  v_sub_f32 v25, v25, v16
  v_mul_f32 v18, s45, v18
  v_mul_f32 v19, s45, v19
  v_mul_f32 v20, s45, v20
  v_mul_f32 v21, s45, v21
  v_mul_f32 v22, s45, v22
  v_mul_f32 v23, s45, v23
  v_mul_f32 v24, s45, v24
  v_mul_f32 v25, s45, v25
  v_exp_f32 v18, v18
  v_exp_f32 v19, v19
  v_exp_f32 v20, v20
  v_exp_f32 v21, v21
  v_exp_f32 v22, v22
  v_exp_f32 v23, v23
  v_exp_f32 v24, v24
  v_exp_f32 v25, v25
  v_add_f32 v26, v18, v19
  v_add_f32 v27, v20, v21
  v_add_f32 v28, v22, v23
  v_add_f32 v29, v24, v25
  v_add_f32 v26, v26, v27
  v_add_f32 v28, v28, v29
  v_add_f32 v26, v26, v28
  v_add_f32 v17, v17, v26
  v_cvt_pk_bf16_f32 v26, v18, 0
  v_cvt_pk_bf16_f32 v27, 0, v18
  v_dot2_f32_bf16 v8, v32, v26, v8
  v_dot2_f32_bf16 v9, v32, v27, v9
  v_dot2_f32_bf16 v10, v33, v26, v10
  v_dot2_f32_bf16 v11, v33, v27, v11
  v_dot2_f32_bf16 v12, v34, v26, v12
  v_dot2_f32_bf16 v13, v34, v27, v13
  v_dot2_f32_bf16 v14, v35, v26, v14
  v_dot2_f32_bf16 v15, v35, v27, v15
  v_cvt_pk_bf16_f32 v28, v19, 0
  v_cvt_pk_bf16_f32 v29, 0, v19
  v_dot2_f32_bf16 v8, v36, v28, v8
  v_dot2_f32_bf16 v9, v36, v29, v9
  v_dot2_f32_bf16 v10, v37, v28, v10
  v_dot2_f32_bf16 v11, v37, v29, v11
  v_dot2_f32_bf16 v12, v38, v28, v12
  v_dot2_f32_bf16 v13, v38, v29, v13
  v_dot2_f32_bf16 v14, v39, v28, v14
  v_dot2_f32_bf16 v15, v39, v29, v15
  v_cvt_pk_bf16_f32 v26, v20, 0
  v_cvt_pk_bf16_f32 v27, 0, v20
  v_dot2_f32_bf16 v8, v40, v26, v8
  v_dot2_f32_bf16 v9, v40, v27, v9
  v_dot2_f32_bf16 v10, v41, v26, v10
  v_dot2_f32_bf16 v11, v41, v27, v11
  v_dot2_f32_bf16 v12, v42, v26, v12
  v_dot2_f32_bf16 v13, v42, v27, v13
  v_dot2_f32_bf16 v14, v43, v26, v14
  v_dot2_f32_bf16 v15, v43, v27, v15
  v_cvt_pk_bf16_f32 v28, v21, 0
  v_cvt_pk_bf16_f32 v29, 0, v21
  v_dot2_f32_bf16 v8, v44, v28, v8
  v_dot2_f32_bf16 v9, v44, v29, v9
  v_dot2_f32_bf16 v10, v45, v28, v10
  v_dot2_f32_bf16 v11, v45, v29, v11
  v_dot2_f32_bf16 v12, v46, v28, v12
  v_dot2_f32_bf16 v13, v46, v29, v13
  v_dot2_f32_bf16 v14, v47, v28, v14
  v_dot2_f32_bf16 v15, v47, v29, v15
  v_cvt_pk_bf16_f32 v26, v22, 0
  v_cvt_pk_bf16_f32 v27, 0, v22
  v_dot2_f32_bf16 v8, v48, v26, v8
  v_dot2_f32_bf16 v9, v48, v27, v9
  v_dot2_f32_bf16 v10, v49, v26, v10
  v_dot2_f32_bf16 v11, v49, v27, v11
  v_dot2_f32_bf16 v12, v50, v26, v12
  v_dot2_f32_bf16 v13, v50, v27, v13
  v_dot2_f32_bf16 v14, v51, v26, v14
  v_dot2_f32_bf16 v15, v51, v27, v15
  v_cvt_pk_bf16_f32 v28, v23, 0
  v_cvt_pk_bf16_f32 v29, 0, v23
  v_dot2_f32_bf16 v8, v52, v28, v8
  v_dot2_f32_bf16 v9, v52, v29, v9
  v_dot2_f32_bf16 v10, v53, v28, v10
  v_dot2_f32_bf16 v11, v53, v29, v11
  v_dot2_f32_bf16 v12, v54, v28, v12
  v_dot2_f32_bf16 v13, v54, v29, v13
  v_dot2_f32_bf16 v14, v55, v28, v14
  v_dot2_f32_bf16 v15, v55, v29, v15
  v_cvt_pk_bf16_f32 v26, v24, 0
  v_cvt_pk_bf16_f32 v27, 0, v24
  v_dot2_f32_bf16 v8, v56, v26, v8
  v_dot2_f32_bf16 v9, v56, v27, v9
  v_dot2_f32_bf16 v10, v57, v26, v10
  v_dot2_f32_bf16 v11, v57, v27, v11
  v_dot2_f32_bf16 v12, v58, v26, v12
  v_dot2_f32_bf16 v13, v58, v27, v13
  v_dot2_f32_bf16 v14, v59, v26, v14
  v_dot2_f32_bf16 v15, v59, v27, v15
  v_cvt_pk_bf16_f32 v28, v25, 0
  v_cvt_pk_bf16_f32 v29, 0, v25
  v_dot2_f32_bf16 v8, v60, v28, v8
  v_dot2_f32_bf16 v9, v60, v29, v9
  v_dot2_f32_bf16 v10, v61, v28, v10
  v_dot2_f32_bf16 v11, v61, v29, v11
  v_dot2_f32_bf16 v12, v62, v28, v12
  v_dot2_f32_bf16 v13, v62, v29, v13
  v_dot2_f32_bf16 v14, v63, v28, v14
  v_dot2_f32_bf16 v15, v63, v29, v15
  s_add_u32 s46, s36, 786432
  buffer_load_dwordx4 v[32:35], v2, s[20:23], s46 offen offset:0 nt
  buffer_load_dwordx4 v[36:39], v2, s[20:23], s46 offen offset:1024 nt
  buffer_load_dwordx4 v[40:43], v2, s[20:23], s46 offen offset:2048 nt
  buffer_load_dwordx4 v[44:47], v2, s[20:23], s46 offen offset:3072 nt
  buffer_load_dwordx4 v[48:51], v3, s[20:23], s46 offen offset:0 nt
  buffer_load_dwordx4 v[52:55], v3, s[20:23], s46 offen offset:1024 nt
  buffer_load_dwordx4 v[56:59], v3, s[20:23], s46 offen offset:2048 nt
  buffer_load_dwordx4 v[60:63], v3, s[20:23], s46 offen offset:3072 nt
  s_waitcnt vmcnt(8)
  v_lshlrev_b32 v18, 16, v116
  v_and_b32 v19, 0xffff0000, v116
  v_lshlrev_b32 v20, 16, v117
  v_and_b32 v21, 0xffff0000, v117
  v_lshlrev_b32 v22, 16, v118
  v_and_b32 v23, 0xffff0000, v118
  v_lshlrev_b32 v24, 16, v119
  v_and_b32 v25, 0xffff0000, v119
  v_sub_f32 v18, v18, v16
  v_sub_f32 v19, v19, v16
  v_sub_f32 v20, v20, v16
  v_sub_f32 v21, v21, v16
  v_sub_f32 v22, v22, v16
  v_sub_f32 v23, v23, v16
  v_sub_f32 v24, v24, v16
  v_sub_f32 v25, v25, v16
  v_mul_f32 v18, s45, v18
  v_mul_f32 v19, s45, v19
  v_mul_f32 v20, s45, v20
  v_mul_f32 v21, s45, v21
  v_mul_f32 v22, s45, v22
  v_mul_f32 v23, s45, v23
  v_mul_f32 v24, s45, v24
  v_mul_f32 v25, s45, v25
  v_exp_f32 v18, v18
  v_exp_f32 v19, v19
  v_exp_f32 v20, v20
  v_exp_f32 v21, v21
  v_exp_f32 v22, v22
  v_exp_f32 v23, v23
  v_exp_f32 v24, v24
  v_exp_f32 v25, v25
  v_add_f32 v26, v18, v19
  v_add_f32 v27, v20, v21
  v_add_f32 v28, v22, v23
  v_add_f32 v29, v24, v25
  v_add_f32 v26, v26, v27
  v_add_f32 v28, v28, v29
  v_add_f32 v26, v26, v28
  v_add_f32 v17, v17, v26
  v_cvt_pk_bf16_f32 v26, v18, 0
  v_cvt_pk_bf16_f32 v27, 0, v18
  v_dot2_f32_bf16 v8, v64, v26, v8
  v_dot2_f32_bf16 v9, v64, v27, v9
  v_dot2_f32_bf16 v10, v65, v26, v10
  v_dot2_f32_bf16 v11, v65, v27, v11
  v_dot2_f32_bf16 v12, v66, v26, v12
  v_dot2_f32_bf16 v13, v66, v27, v13
  v_dot2_f32_bf16 v14, v67, v26, v14
  v_dot2_f32_bf16 v15, v67, v27, v15
  v_cvt_pk_bf16_f32 v28, v19, 0
  v_cvt_pk_bf16_f32 v29, 0, v19
  v_dot2_f32_bf16 v8, v68, v28, v8
  v_dot2_f32_bf16 v9, v68, v29, v9
  v_dot2_f32_bf16 v10, v69, v28, v10
  v_dot2_f32_bf16 v11, v69, v29, v11
  v_dot2_f32_bf16 v12, v70, v28, v12
  v_dot2_f32_bf16 v13, v70, v29, v13
  v_dot2_f32_bf16 v14, v71, v28, v14
  v_dot2_f32_bf16 v15, v71, v29, v15
  v_cvt_pk_bf16_f32 v26, v20, 0
  v_cvt_pk_bf16_f32 v27, 0, v20
  v_dot2_f32_bf16 v8, v72, v26, v8
  v_dot2_f32_bf16 v9, v72, v27, v9
  v_dot2_f32_bf16 v10, v73, v26, v10
  v_dot2_f32_bf16 v11, v73, v27, v11
  v_dot2_f32_bf16 v12, v74, v26, v12
  v_dot2_f32_bf16 v13, v74, v27, v13
  v_dot2_f32_bf16 v14, v75, v26, v14
  v_dot2_f32_bf16 v15, v75, v27, v15
  v_cvt_pk_bf16_f32 v28, v21, 0
  v_cvt_pk_bf16_f32 v29, 0, v21
  v_dot2_f32_bf16 v8, v76, v28, v8
  v_dot2_f32_bf16 v9, v76, v29, v9
  v_dot2_f32_bf16 v10, v77, v28, v10
  v_dot2_f32_bf16 v11, v77, v29, v11
  v_dot2_f32_bf16 v12, v78, v28, v12
  v_dot2_f32_bf16 v13, v78, v29, v13
  v_dot2_f32_bf16 v14, v79, v28, v14
  v_dot2_f32_bf16 v15, v79, v29, v15
  v_cvt_pk_bf16_f32 v26, v22, 0
  v_cvt_pk_bf16_f32 v27, 0, v22
  v_dot2_f32_bf16 v8, v80, v26, v8
  v_dot2_f32_bf16 v9, v80, v27, v9
  v_dot2_f32_bf16 v10, v81, v26, v10
  v_dot2_f32_bf16 v11, v81, v27, v11
  v_dot2_f32_bf16 v12, v82, v26, v12
  v_dot2_f32_bf16 v13, v82, v27, v13
  v_dot2_f32_bf16 v14, v83, v26, v14
  v_dot2_f32_bf16 v15, v83, v27, v15
  v_cvt_pk_bf16_f32 v28, v23, 0
  v_cvt_pk_bf16_f32 v29, 0, v23
  v_dot2_f32_bf16 v8, v84, v28, v8
  v_dot2_f32_bf16 v9, v84, v29, v9
  v_dot2_f32_bf16 v10, v85, v28, v10
  v_dot2_f32_bf16 v11, v85, v29, v11
  v_dot2_f32_bf16 v12, v86, v28, v12
  v_dot2_f32_bf16 v13, v86, v29, v13
  v_dot2_f32_bf16 v14, v87, v28, v14
  v_dot2_f32_bf16 v15, v87, v29, v15
  v_cvt_pk_bf16_f32 v26, v24, 0
  v_cvt_pk_bf16_f32 v27, 0, v24
  v_dot2_f32_bf16 v8, v88, v26, v8
  v_dot2_f32_bf16 v9, v88, v27, v9
  v_dot2_f32_bf16 v10, v89, v26, v10
  v_dot2_f32_bf16 v11, v89, v27, v11
  v_dot2_f32_bf16 v12, v90, v26, v12
  v_dot2_f32_bf16 v13, v90, v27, v13
  v_dot2_f32_bf16 v14, v91, v26, v14
  v_dot2_f32_bf16 v15, v91, v27, v15
  v_cvt_pk_bf16_f32 v28, v25, 0
  v_cvt_pk_bf16_f32 v29, 0, v25
  v_dot2_f32_bf16 v8, v92, v28, v8
  v_dot2_f32_bf16 v9, v92, v29, v9
  v_dot2_f32_bf16 v10, v93, v28, v10
  v_dot2_f32_bf16 v11, v93, v29, v11
  v_dot2_f32_bf16 v12, v94, v28, v12
  v_dot2_f32_bf16 v13, v94, v29, v13
  v_dot2_f32_bf16 v14, v95, v28, v14
  v_dot2_f32_bf16 v15, v95, v29, v15
  s_add_u32 s46, s36, 917504
  buffer_load_dwordx4 v[64:67], v2, s[20:23], s46 offen offset:0 nt
  buffer_load_dwordx4 v[68:71], v2, s[20:23], s46 offen offset:1024 nt
  buffer_load_dwordx4 v[72:75], v2, s[20:23], s46 offen offset:2048 nt
  buffer_load_dwordx4 v[76:79], v2, s[20:23], s46 offen offset:3072 nt
  buffer_load_dwordx4 v[80:83], v3, s[20:23], s46 offen offset:0 nt
  buffer_load_dwordx4 v[84:87], v3, s[20:23], s46 offen offset:1024 nt
  buffer_load_dwordx4 v[88:91], v3, s[20:23], s46 offen offset:2048 nt
  buffer_load_dwordx4 v[92:95], v3, s[20:23], s46 offen offset:3072 nt
  s_waitcnt vmcnt(8)
  v_lshlrev_b32 v18, 16, v120
  v_and_b32 v19, 0xffff0000, v120
  v_lshlrev_b32 v20, 16, v121
  v_and_b32 v21, 0xffff0000, v121
  v_lshlrev_b32 v22, 16, v122
  v_and_b32 v23, 0xffff0000, v122
  v_lshlrev_b32 v24, 16, v123
  v_and_b32 v25, 0xffff0000, v123
  v_sub_f32 v18, v18, v16
  v_sub_f32 v19, v19, v16
  v_sub_f32 v20, v20, v16
  v_sub_f32 v21, v21, v16
  v_sub_f32 v22, v22, v16
  v_sub_f32 v23, v23, v16
  v_sub_f32 v24, v24, v16
  v_sub_f32 v25, v25, v16
  v_mul_f32 v18, s45, v18
  v_mul_f32 v19, s45, v19
  v_mul_f32 v20, s45, v20
  v_mul_f32 v21, s45, v21
  v_mul_f32 v22, s45, v22
  v_mul_f32 v23, s45, v23
  v_mul_f32 v24, s45, v24
  v_mul_f32 v25, s45, v25
  v_exp_f32 v18, v18
  v_exp_f32 v19, v19
  v_exp_f32 v20, v20
  v_exp_f32 v21, v21
  v_exp_f32 v22, v22
  v_exp_f32 v23, v23
  v_exp_f32 v24, v24
  v_exp_f32 v25, v25
  v_add_f32 v26, v18, v19
  v_add_f32 v27, v20, v21
  v_add_f32 v28, v22, v23
  v_add_f32 v29, v24, v25
  v_add_f32 v26, v26, v27
  v_add_f32 v28, v28, v29
  v_add_f32 v26, v26, v28
  v_add_f32 v17, v17, v26
  v_cvt_pk_bf16_f32 v26, v18, 0
  v_cvt_pk_bf16_f32 v27, 0, v18
  v_dot2_f32_bf16 v8, v32, v26, v8
  v_dot2_f32_bf16 v9, v32, v27, v9
  v_dot2_f32_bf16 v10, v33, v26, v10
  v_dot2_f32_bf16 v11, v33, v27, v11
  v_dot2_f32_bf16 v12, v34, v26, v12
  v_dot2_f32_bf16 v13, v34, v27, v13
  v_dot2_f32_bf16 v14, v35, v26, v14
  v_dot2_f32_bf16 v15, v35, v27, v15
  v_cvt_pk_bf16_f32 v28, v19, 0
  v_cvt_pk_bf16_f32 v29, 0, v19
  v_dot2_f32_bf16 v8, v36, v28, v8
  v_dot2_f32_bf16 v9, v36, v29, v9
  v_dot2_f32_bf16 v10, v37, v28, v10
  v_dot2_f32_bf16 v11, v37, v29, v11
  v_dot2_f32_bf16 v12, v38, v28, v12
  v_dot2_f32_bf16 v13, v38, v29, v13
  v_dot2_f32_bf16 v14, v39, v28, v14
  v_dot2_f32_bf16 v15, v39, v29, v15
  v_cvt_pk_bf16_f32 v26, v20, 0
  v_cvt_pk_bf16_f32 v27, 0, v20
  v_dot2_f32_bf16 v8, v40, v26, v8
  v_dot2_f32_bf16 v9, v40, v27, v9
  v_dot2_f32_bf16 v10, v41, v26, v10
  v_dot2_f32_bf16 v11, v41, v27, v11
  v_dot2_f32_bf16 v12, v42, v26, v12
  v_dot2_f32_bf16 v13, v42, v27, v13
  v_dot2_f32_bf16 v14, v43, v26, v14
  v_dot2_f32_bf16 v15, v43, v27, v15
  v_cvt_pk_bf16_f32 v28, v21, 0
  v_cvt_pk_bf16_f32 v29, 0, v21
  v_dot2_f32_bf16 v8, v44, v28, v8
  v_dot2_f32_bf16 v9, v44, v29, v9
  v_dot2_f32_bf16 v10, v45, v28, v10
  v_dot2_f32_bf16 v11, v45, v29, v11
  v_dot2_f32_bf16 v12, v46, v28, v12
  v_dot2_f32_bf16 v13, v46, v29, v13
  v_dot2_f32_bf16 v14, v47, v28, v14
  v_dot2_f32_bf16 v15, v47, v29, v15
  v_cvt_pk_bf16_f32 v26, v22, 0
  v_cvt_pk_bf16_f32 v27, 0, v22
  v_dot2_f32_bf16 v8, v48, v26, v8
  v_dot2_f32_bf16 v9, v48, v27, v9
  v_dot2_f32_bf16 v10, v49, v26, v10
  v_dot2_f32_bf16 v11, v49, v27, v11
  v_dot2_f32_bf16 v12, v50, v26, v12
  v_dot2_f32_bf16 v13, v50, v27, v13
  v_dot2_f32_bf16 v14, v51, v26, v14
  v_dot2_f32_bf16 v15, v51, v27, v15
  v_cvt_pk_bf16_f32 v28, v23, 0
  v_cvt_pk_bf16_f32 v29, 0, v23
  v_dot2_f32_bf16 v8, v52, v28, v8
  v_dot2_f32_bf16 v9, v52, v29, v9
  v_dot2_f32_bf16 v10, v53, v28, v10
  v_dot2_f32_bf16 v11, v53, v29, v11
  v_dot2_f32_bf16 v12, v54, v28, v12
  v_dot2_f32_bf16 v13, v54, v29, v13
  v_dot2_f32_bf16 v14, v55, v28, v14
  v_dot2_f32_bf16 v15, v55, v29, v15
  v_cvt_pk_bf16_f32 v26, v24, 0
  v_cvt_pk_bf16_f32 v27, 0, v24
  v_dot2_f32_bf16 v8, v56, v26, v8
  v_dot2_f32_bf16 v9, v56, v27, v9
  v_dot2_f32_bf16 v10, v57, v26, v10
  v_dot2_f32_bf16 v11, v57, v27, v11
  v_dot2_f32_bf16 v12, v58, v26, v12
  v_dot2_f32_bf16 v13, v58, v27, v13
  v_dot2_f32_bf16 v14, v59, v26, v14
  v_dot2_f32_bf16 v15, v59, v27, v15
  v_cvt_pk_bf16_f32 v28, v25, 0
  v_cvt_pk_bf16_f32 v29, 0, v25
  v_dot2_f32_bf16 v8, v60, v28, v8
  v_dot2_f32_bf16 v9, v60, v29, v9
  v_dot2_f32_bf16 v10, v61, v28, v10
  v_dot2_f32_bf16 v11, v61, v29, v11
  v_dot2_f32_bf16 v12, v62, v28, v12
  v_dot2_f32_bf16 v13, v62, v29, v13
  v_dot2_f32_bf16 v14, v63, v28, v14
  v_dot2_f32_bf16 v15, v63, v29, v15
  s_waitcnt vmcnt(0)
  v_lshlrev_b32 v18, 16, v124
  v_and_b32 v19, 0xffff0000, v124
  v_lshlrev_b32 v20, 16, v125
  v_and_b32 v21, 0xffff0000, v125
  v_lshlrev_b32 v22, 16, v126
  v_and_b32 v23, 0xffff0000, v126
  v_lshlrev_b32 v24, 16, v127
  v_and_b32 v25, 0xffff0000, v127
  v_sub_f32 v18, v18, v16
  v_sub_f32 v19, v19, v16
  v_sub_f32 v20, v20, v16
  v_sub_f32 v21, v21, v16
  v_sub_f32 v22, v22, v16
  v_sub_f32 v23, v23, v16
  v_sub_f32 v24, v24, v16
  v_sub_f32 v25, v25, v16
  v_mul_f32 v18, s45, v18
  v_mul_f32 v19, s45, v19
  v_mul_f32 v20, s45, v20
  v_mul_f32 v21, s45, v21
  v_mul_f32 v22, s45, v22
  v_mul_f32 v23, s45, v23
  v_mul_f32 v24, s45, v24
  v_mul_f32 v25, s45, v25
  v_exp_f32 v18, v18
  v_exp_f32 v19, v19
  v_exp_f32 v20, v20
  v_exp_f32 v21, v21
  v_exp_f32 v22, v22
  v_exp_f32 v23, v23
  v_exp_f32 v24, v24
  v_exp_f32 v25, v25
  v_add_f32 v26, v18, v19
  v_add_f32 v27, v20, v21
  v_add_f32 v28, v22, v23
  v_add_f32 v29, v24, v25
  v_add_f32 v26, v26, v27
  v_add_f32 v28, v28, v29
  v_add_f32 v26, v26, v28
  v_add_f32 v17, v17, v26
  v_cvt_pk_bf16_f32 v26, v18, 0
  v_cvt_pk_bf16_f32 v27, 0, v18
  v_dot2_f32_bf16 v8, v64, v26, v8
  v_dot2_f32_bf16 v9, v64, v27, v9
  v_dot2_f32_bf16 v10, v65, v26, v10
  v_dot2_f32_bf16 v11, v65, v27, v11
  v_dot2_f32_bf16 v12, v66, v26, v12
  v_dot2_f32_bf16 v13, v66, v27, v13
  v_dot2_f32_bf16 v14, v67, v26, v14
  v_dot2_f32_bf16 v15, v67, v27, v15
  v_cvt_pk_bf16_f32 v28, v19, 0
  v_cvt_pk_bf16_f32 v29, 0, v19
  v_dot2_f32_bf16 v8, v68, v28, v8
  v_dot2_f32_bf16 v9, v68, v29, v9
  v_dot2_f32_bf16 v10, v69, v28, v10
  v_dot2_f32_bf16 v11, v69, v29, v11
  v_dot2_f32_bf16 v12, v70, v28, v12
  v_dot2_f32_bf16 v13, v70, v29, v13
  v_dot2_f32_bf16 v14, v71, v28, v14
  v_dot2_f32_bf16 v15, v71, v29, v15
  v_cvt_pk_bf16_f32 v26, v20, 0
  v_cvt_pk_bf16_f32 v27, 0, v20
  v_dot2_f32_bf16 v8, v72, v26, v8
  v_dot2_f32_bf16 v9, v72, v27, v9
  v_dot2_f32_bf16 v10, v73, v26, v10
  v_dot2_f32_bf16 v11, v73, v27, v11
  v_dot2_f32_bf16 v12, v74, v26, v12
  v_dot2_f32_bf16 v13, v74, v27, v13
  v_dot2_f32_bf16 v14, v75, v26, v14
  v_dot2_f32_bf16 v15, v75, v27, v15
  v_cvt_pk_bf16_f32 v28, v21, 0
  v_cvt_pk_bf16_f32 v29, 0, v21
  v_dot2_f32_bf16 v8, v76, v28, v8
  v_dot2_f32_bf16 v9, v76, v29, v9
  v_dot2_f32_bf16 v10, v77, v28, v10
  v_dot2_f32_bf16 v11, v77, v29, v11
  v_dot2_f32_bf16 v12, v78, v28, v12
  v_dot2_f32_bf16 v13, v78, v29, v13
  v_dot2_f32_bf16 v14, v79, v28, v14
  v_dot2_f32_bf16 v15, v79, v29, v15
  v_cvt_pk_bf16_f32 v26, v22, 0
  v_cvt_pk_bf16_f32 v27, 0, v22
  v_dot2_f32_bf16 v8, v80, v26, v8
  v_dot2_f32_bf16 v9, v80, v27, v9
  v_dot2_f32_bf16 v10, v81, v26, v10
  v_dot2_f32_bf16 v11, v81, v27, v11
  v_dot2_f32_bf16 v12, v82, v26, v12
  v_dot2_f32_bf16 v13, v82, v27, v13
  v_dot2_f32_bf16 v14, v83, v26, v14
  v_dot2_f32_bf16 v15, v83, v27, v15
  v_cvt_pk_bf16_f32 v28, v23, 0
  v_cvt_pk_bf16_f32 v29, 0, v23
  v_dot2_f32_bf16 v8, v84, v28, v8
  v_dot2_f32_bf16 v9, v84, v29, v9
  v_dot2_f32_bf16 v10, v85, v28, v10
  v_dot2_f32_bf16 v11, v85, v29, v11
  v_dot2_f32_bf16 v12, v86, v28, v12
  v_dot2_f32_bf16 v13, v86, v29, v13
  v_dot2_f32_bf16 v14, v87, v28, v14
  v_dot2_f32_bf16 v15, v87, v29, v15
  v_cvt_pk_bf16_f32 v26, v24, 0
  v_cvt_pk_bf16_f32 v27, 0, v24
  v_dot2_f32_bf16 v8, v88, v26, v8
  v_dot2_f32_bf16 v9, v88, v27, v9
  v_dot2_f32_bf16 v10, v89, v26, v10
  v_dot2_f32_bf16 v11, v89, v27, v11
  v_dot2_f32_bf16 v12, v90, v26, v12
  v_dot2_f32_bf16 v13, v90, v27, v13
  v_dot2_f32_bf16 v14, v91, v26, v14
  v_dot2_f32_bf16 v15, v91, v27, v15
  v_cvt_pk_bf16_f32 v28, v25, 0
  v_cvt_pk_bf16_f32 v29, 0, v25
  v_dot2_f32_bf16 v8, v92, v28, v8
  v_dot2_f32_bf16 v9, v92, v29, v9
  v_dot2_f32_bf16 v10, v93, v28, v10
  v_dot2_f32_bf16 v11, v93, v29, v11
  v_dot2_f32_bf16 v12, v94, v28, v12
  v_dot2_f32_bf16 v13, v94, v29, v13
  v_dot2_f32_bf16 v14, v95, v28, v14
  v_dot2_f32_bf16 v15, v95, v29, v15
  v_lshrrev_b32 v26, 6, v0
  v_and_b32 v24, 127, v0
  v_lshrrev_b32 v25, 7, v0
  v_lshlrev_b32 v24, 2, v24
  v_lshl_add_u32 v31, v25, 12, v24
A_epi:
  s_nop 3
  v_mov_b32 v20, v16
  s_nop 1
  v_readlane_b32 s48, v20, 0
  v_readlane_b32 s49, v20, 16
  v_readlane_b32 s50, v20, 32
  v_readlane_b32 s51, v20, 48
  s_nop 1
  v_mov_b32 v20, s48
  v_max_f32 v20, s49, v20
  v_max_f32 v20, s50, v20
  v_max_f32 v20, s51, v20
  v_sub_f32 v21, v16, v20
  v_mul_f32 v21, s45, v21
  v_exp_f32 v21, v21
  s_nop 0
  v_mul_f32 v17, v17, v21
  v_mul_f32 v8, v8, v21
  v_mul_f32 v9, v9, v21
  v_mul_f32 v10, v10, v21
  v_mul_f32 v11, v11, v21
  v_mul_f32 v12, v12, v21
  v_mul_f32 v13, v13, v21
  v_mul_f32 v14, v14, v21
  v_mul_f32 v15, v15, v21
  s_nop 1
  v_readlane_b32 s48, v17, 0
  v_readlane_b32 s49, v17, 16
  v_readlane_b32 s50, v17, 32
  v_readlane_b32 s51, v17, 48
  s_nop 1
  v_mov_b32 v17, s48
  v_add_f32 v17, s49, v17
  v_add_f32 v17, s50, v17
  v_add_f32 v17, s51, v17
  v_lshlrev_b32 v30, 5, v0
  ds_write_b128 v30, v[8:11] offset:0
  ds_write_b128 v30, v[12:15] offset:16
  v_lshlrev_b32 v29, 2, v26
  ds_write_b32 v29, v20 offset:36864
  ds_write_b32 v29, v17 offset:36928
  v_mov_b32 v24, 0
  v_lshrrev_b32 v25, 7, v0
  v_lshlrev_b32 v28, 3, v25
  s_waitcnt lgkmcnt(0)
  s_barrier
  ds_read_b128 v[32:35], v24 offset:36864
  ds_read_b128 v[36:39], v24 offset:36880
  ds_read_b128 v[40:43], v24 offset:36896
  ds_read_b128 v[44:47], v24 offset:36912
  ds_read_b64 v[48:49], v28 offset:36864
  ds_read_b32 v50, v31 offset:0
  ds_read_b32 v51, v31 offset:512
  ds_read_b32 v52, v31 offset:1024
  ds_read_b32 v53, v31 offset:1536
  ds_read_b32 v54, v31 offset:2048
  ds_read_b32 v55, v31 offset:2560
  ds_read_b32 v56, v31 offset:3072
  ds_read_b32 v57, v31 offset:3584
  s_waitcnt lgkmcnt(0)
  v_max3_f32 v60, v32, v33, v34
  v_max3_f32 v60, v60, v35, v36
  v_max3_f32 v60, v60, v37, v38
  v_max3_f32 v60, v60, v39, v40
  v_max3_f32 v60, v60, v41, v42
  v_max3_f32 v60, v60, v43, v44
  v_max3_f32 v60, v60, v45, v46
  v_max_f32 v60, v60, v47
  v_sub_f32 v48, v48, v60
  v_sub_f32 v49, v49, v60
  v_mul_f32 v48, s45, v48
  v_mul_f32 v49, s45, v49
  v_exp_f32 v48, v48
  v_exp_f32 v49, v49
  v_add_f32 v50, v50, v51
  v_add_f32 v52, v52, v53
  v_add_f32 v54, v54, v55
  v_add_f32 v56, v56, v57
  v_add_f32 v50, v50, v52
  v_add_f32 v54, v54, v56
  v_mul_f32 v50, v50, v48
  v_fmac_f32 v50, v54, v49
  v_lshlrev_b32 v29, 2, v0
  ds_write_b32 v29, v50 offset:32768
  s_waitcnt lgkmcnt(0)
  s_barrier
  v_cmp_gt_u32 vcc, 128, v0
  s_and_saveexec_b64 s[42:43], vcc
  s_cbranch_execz A_end
  ds_read_b32 v50, v29 offset:32768
  ds_read_b32 v51, v29 offset:33280
  ds_read_b32 v52, v29 offset:33792
  ds_read_b32 v53, v29 offset:34304
  ds_read_b32 v54, v29 offset:34816
  ds_read_b32 v55, v29 offset:35328
  ds_read_b32 v56, v29 offset:35840
  ds_read_b32 v57, v29 offset:36352
  ds_read_b128 v[64:67], v24 offset:36928
  ds_read_b128 v[68:71], v24 offset:36944
  ds_read_b128 v[72:75], v24 offset:36960
  ds_read_b128 v[76:79], v24 offset:36976
  s_waitcnt lgkmcnt(0)
  v_add_f32 v50, v50, v51
  v_add_f32 v50, v50, v52
  v_add_f32 v50, v50, v53
  v_add_f32 v50, v50, v54
  v_add_f32 v50, v50, v55
  v_add_f32 v50, v50, v56
  v_add_f32 v50, v50, v57
  v_mov_b32 v61, 0
  v_sub_f32 v32, v32, v60
  v_mul_f32 v32, s45, v32
  v_exp_f32 v32, v32
  s_nop 0
  v_fmac_f32 v61, v32, v64
  v_sub_f32 v33, v33, v60
  v_mul_f32 v33, s45, v33
  v_exp_f32 v33, v33
  s_nop 0
  v_fmac_f32 v61, v33, v65
  v_sub_f32 v34, v34, v60
  v_mul_f32 v34, s45, v34
  v_exp_f32 v34, v34
  s_nop 0
  v_fmac_f32 v61, v34, v66
  v_sub_f32 v35, v35, v60
  v_mul_f32 v35, s45, v35
  v_exp_f32 v35, v35
  s_nop 0
  v_fmac_f32 v61, v35, v67
  v_sub_f32 v36, v36, v60
  v_mul_f32 v36, s45, v36
  v_exp_f32 v36, v36
  s_nop 0
  v_fmac_f32 v61, v36, v68
  v_sub_f32 v37, v37, v60
  v_mul_f32 v37, s45, v37
  v_exp_f32 v37, v37
  s_nop 0
  v_fmac_f32 v61, v37, v69
  v_sub_f32 v38, v38, v60
  v_mul_f32 v38, s45, v38
  v_exp_f32 v38, v38
  s_nop 0
  v_fmac_f32 v61, v38, v70
  v_sub_f32 v39, v39, v60
  v_mul_f32 v39, s45, v39
  v_exp_f32 v39, v39
  s_nop 0
  v_fmac_f32 v61, v39, v71
  v_sub_f32 v40, v40, v60
  v_mul_f32 v40, s45, v40
  v_exp_f32 v40, v40
  s_nop 0
  v_fmac_f32 v61, v40, v72
  v_sub_f32 v41, v41, v60
  v_mul_f32 v41, s45, v41
  v_exp_f32 v41, v41
  s_nop 0
  v_fmac_f32 v61, v41, v73
  v_sub_f32 v42, v42, v60
  v_mul_f32 v42, s45, v42
  v_exp_f32 v42, v42
  s_nop 0
  v_fmac_f32 v61, v42, v74
  v_sub_f32 v43, v43, v60
  v_mul_f32 v43, s45, v43
  v_exp_f32 v43, v43
  s_nop 0
  v_fmac_f32 v61, v43, v75
  v_sub_f32 v44, v44, v60
  v_mul_f32 v44, s45, v44
  v_exp_f32 v44, v44
  s_nop 0
  v_fmac_f32 v61, v44, v76
  v_sub_f32 v45, v45, v60
  v_mul_f32 v45, s45, v45
  v_exp_f32 v45, v45
  s_nop 0
  v_fmac_f32 v61, v45, v77
  v_sub_f32 v46, v46, v60
  v_mul_f32 v46, s45, v46
  v_exp_f32 v46, v46
  s_nop 0
  v_fmac_f32 v61, v46, v78
  v_sub_f32 v47, v47, v60
  v_mul_f32 v47, s45, v47
  v_exp_f32 v47, v47
  s_nop 0
  v_fmac_f32 v61, v47, v79
  s_lshl_b32 s47, s74, 10
  buffer_store_dword v50, v29, s[32:35], s47 offen
  v_cmp_eq_u32 vcc, 0, v0
  s_and_saveexec_b64 s[42:43], vcc
  s_cbranch_execz A_end
  buffer_store_dwordx2 v[60:61], v24, s[32:35], s47 offen offset:512
A_end:
  s_endpgm
.globl proj_kernel
.p2align 8
.type proj_kernel,@function
proj_kernel:
  s_cmp_ge_u32 s2, 171
  s_cbranch_scc1 B_end
  s_load_dwordx2 s[4:5], s[0:1], 0
  s_load_dwordx2 s[6:7], s[0:1], 32
  s_load_dwordx4 s[8:11], s[0:1], 48
  s_load_dwordx2 s[12:13], s[0:1], 64
  s_load_dwordx2 s[14:15], s[0:1], 88
  s_load_dwordx4 s[48:51], s[0:1], 72
  v_and_b32 v1, 63, v0
  v_lshrrev_b32 v2, 6, v0
  s_mov_b32 s45, 0x3fb8aa3b
  s_waitcnt lgkmcnt(0)
  s_mov_b32 s20, s14
  s_and_b32 s21, s15, 0xffff
  s_mov_b32 s22, 1073741824
  s_mov_b32 s23, 0x00020000
  s_cmp_ge_u32 s2, 128
  s_cbranch_scc1 B_ffn
  s_mov_b32 s16, s6
  s_and_b32 s17, s7, 0xffff
  s_mov_b32 s18, 4194304
  s_mov_b32 s19, 0x00020000
  s_lshr_b32 s36, s2, 3
  s_and_b32 s37, s2, 7
  s_lshl_b32 s38, s36, 18
  s_lshl_b32 s39, s37, 7
  s_add_u32 s38, s38, s39
  s_lshl_b32 s40, s36, 13
  v_lshrrev_b32 v3, 1, v2
  v_and_b32 v4, 1, v2
  v_lshlrev_b32 v5, 17, v3
  v_lshl_add_u32 v5, v4, 12, v5
  v_lshl_add_u32 v6, v1, 3, v5
  buffer_load_dwordx2 v[64:65], v6, s[20:23], s40 offen offset:0
  buffer_load_dwordx2 v[72:73], v5, s[20:23], s40 offen offset:512
  buffer_load_dwordx2 v[66:67], v6, s[20:23], s40 offen offset:1024
  buffer_load_dwordx2 v[74:75], v5, s[20:23], s40 offen offset:1536
  buffer_load_dwordx2 v[68:69], v6, s[20:23], s40 offen offset:2048
  buffer_load_dwordx2 v[76:77], v5, s[20:23], s40 offen offset:2560
  buffer_load_dwordx2 v[70:71], v6, s[20:23], s40 offen offset:3072
  buffer_load_dwordx2 v[78:79], v5, s[20:23], s40 offen offset:3584
  v_lshrrev_b32 v7, 3, v0
  v_and_b32 v8, 7, v0
  v_lshlrev_b32 v8, 4, v8
  v_lshl_add_u32 v9, v7, 10, v8
  buffer_load_dwordx4 v[32:35], v9, s[16:19], s38 offen nt
  s_add_u32 s38, s38, 0x8000
  buffer_load_dwordx4 v[36:39], v9, s[16:19], s38 offen nt
  s_add_u32 s38, s38, 0x8000
  buffer_load_dwordx4 v[40:43], v9, s[16:19], s38 offen nt
  s_add_u32 s38, s38, 0x8000
  buffer_load_dwordx4 v[44:47], v9, s[16:19], s38 offen nt
  s_add_u32 s38, s38, 0x8000
  buffer_load_dwordx4 v[48:51], v9, s[16:19], s38 offen nt
  s_add_u32 s38, s38, 0x8000
  buffer_load_dwordx4 v[52:55], v9, s[16:19], s38 offen nt
  s_add_u32 s38, s38, 0x8000
  buffer_load_dwordx4 v[56:59], v9, s[16:19], s38 offen nt
  s_add_u32 s38, s38, 0x8000
  buffer_load_dwordx4 v[60:63], v9, s[16:19], s38 offen nt
  s_waitcnt vmcnt(8)
  v_max3_f32 v10, v72, v74, v76
  v_max_f32 v10, v10, v78
  v_sub_f32 v72, v72, v10
  v_mul_f32 v72, s45, v72
  v_exp_f32 v72, v72
  v_sub_f32 v74, v74, v10
  v_mul_f32 v74, s45, v74
  v_exp_f32 v74, v74
  v_sub_f32 v76, v76, v10
  v_mul_f32 v76, s45, v76
  v_exp_f32 v76, v76
  v_sub_f32 v78, v78, v10
  v_mul_f32 v78, s45, v78
  v_exp_f32 v78, v78
  s_nop 0
  v_mul_f32 v11, v72, v73
  v_mul_f32 v12, v72, v64
  v_mul_f32 v13, v72, v65
  v_fmac_f32 v11, v74, v75
  v_fmac_f32 v12, v74, v66
  v_fmac_f32 v13, v74, v67
  v_fmac_f32 v11, v76, v77
  v_fmac_f32 v12, v76, v68
  v_fmac_f32 v13, v76, v69
  v_fmac_f32 v11, v78, v79
  v_fmac_f32 v12, v78, v70
  v_fmac_f32 v13, v78, v71
  v_rcp_f32 v14, v11
  s_nop 0
  v_mul_f32 v15, v12, v14
  v_fma_f32 v16, -v15, v11, v12
  v_fma_f32 v15, v16, v14, v15
  v_cvt_pk_bf16_f32 v12, v15, v15
  v_lshlrev_b32 v12, 16, v12
  v_mul_f32 v15, v13, v14
  v_fma_f32 v16, -v15, v11, v13
  v_fma_f32 v15, v16, v14, v15
  v_cvt_pk_bf16_f32 v13, v15, v15
  v_lshlrev_b32 v13, 16, v13
  v_lshlrev_b32 v15, 10, v4
  v_lshl_add_u32 v15, v1, 4, v15
  v_lshl_add_u32 v15, v3, 2, v15
  ds_write_b32 v15, v12 offset:0
  ds_write_b32 v15, v13 offset:8
  v_lshlrev_b32 v16, 3, v7
  v_mov_b32 v96, 0
  v_mov_b32 v97, 0
  v_mov_b32 v98, 0
  v_mov_b32 v99, 0
  v_mov_b32 v100, 0
  v_mov_b32 v101, 0
  v_mov_b32 v102, 0
  v_mov_b32 v103, 0
  v_mov_b32 v104, 0
  v_mov_b32 v105, 0
  v_mov_b32 v106, 0
  v_mov_b32 v107, 0
  v_mov_b32 v108, 0
  v_mov_b32 v109, 0
  v_mov_b32 v110, 0
  v_mov_b32 v111, 0
  s_waitcnt lgkmcnt(0)
  s_barrier
  ds_read_b64 v[64:65], v16 offset:0
  ds_read_b64 v[66:67], v16 offset:256
  ds_read_b64 v[68:69], v16 offset:512
  ds_read_b64 v[70:71], v16 offset:768
  ds_read_b64 v[72:73], v16 offset:1024
  ds_read_b64 v[74:75], v16 offset:1280
  ds_read_b64 v[76:77], v16 offset:1536
  ds_read_b64 v[78:79], v16 offset:1792
  s_waitcnt vmcnt(0) lgkmcnt(0)
  v_lshlrev_b32 v18, 16, v32
  v_and_b32 v19, 0xffff0000, v32
  v_fmac_f32 v96, v18, v64
  v_fmac_f32 v97, v19, v64
  v_fmac_f32 v104, v18, v65
  v_fmac_f32 v105, v19, v65
  v_lshlrev_b32 v18, 16, v33
  v_and_b32 v19, 0xffff0000, v33
  v_fmac_f32 v98, v18, v64
  v_fmac_f32 v99, v19, v64
  v_fmac_f32 v106, v18, v65
  v_fmac_f32 v107, v19, v65
  v_lshlrev_b32 v18, 16, v34
  v_and_b32 v19, 0xffff0000, v34
  v_fmac_f32 v100, v18, v64
  v_fmac_f32 v101, v19, v64
  v_fmac_f32 v108, v18, v65
  v_fmac_f32 v109, v19, v65
  v_lshlrev_b32 v18, 16, v35
  v_and_b32 v19, 0xffff0000, v35
  v_fmac_f32 v102, v18, v64
  v_fmac_f32 v103, v19, v64
  v_fmac_f32 v110, v18, v65
  v_fmac_f32 v111, v19, v65
  v_lshlrev_b32 v18, 16, v36
  v_and_b32 v19, 0xffff0000, v36
  v_fmac_f32 v96, v18, v66
  v_fmac_f32 v97, v19, v66
  v_fmac_f32 v104, v18, v67
  v_fmac_f32 v105, v19, v67
  v_lshlrev_b32 v18, 16, v37
  v_and_b32 v19, 0xffff0000, v37
  v_fmac_f32 v98, v18, v66
  v_fmac_f32 v99, v19, v66
  v_fmac_f32 v106, v18, v67
  v_fmac_f32 v107, v19, v67
  v_lshlrev_b32 v18, 16, v38
  v_and_b32 v19, 0xffff0000, v38
  v_fmac_f32 v100, v18, v66
  v_fmac_f32 v101, v19, v66
  v_fmac_f32 v108, v18, v67
  v_fmac_f32 v109, v19, v67
  v_lshlrev_b32 v18, 16, v39
  v_and_b32 v19, 0xffff0000, v39
  v_fmac_f32 v102, v18, v66
  v_fmac_f32 v103, v19, v66
  v_fmac_f32 v110, v18, v67
  v_fmac_f32 v111, v19, v67
  v_lshlrev_b32 v18, 16, v40
  v_and_b32 v19, 0xffff0000, v40
  v_fmac_f32 v96, v18, v68
  v_fmac_f32 v97, v19, v68
  v_fmac_f32 v104, v18, v69
  v_fmac_f32 v105, v19, v69
  v_lshlrev_b32 v18, 16, v41
  v_and_b32 v19, 0xffff0000, v41
  v_fmac_f32 v98, v18, v68
  v_fmac_f32 v99, v19, v68
  v_fmac_f32 v106, v18, v69
  v_fmac_f32 v107, v19, v69
  v_lshlrev_b32 v18, 16, v42
  v_and_b32 v19, 0xffff0000, v42
  v_fmac_f32 v100, v18, v68
  v_fmac_f32 v101, v19, v68
  v_fmac_f32 v108, v18, v69
  v_fmac_f32 v109, v19, v69
  v_lshlrev_b32 v18, 16, v43
  v_and_b32 v19, 0xffff0000, v43
  v_fmac_f32 v102, v18, v68
  v_fmac_f32 v103, v19, v68
  v_fmac_f32 v110, v18, v69
  v_fmac_f32 v111, v19, v69
  v_lshlrev_b32 v18, 16, v44
  v_and_b32 v19, 0xffff0000, v44
  v_fmac_f32 v96, v18, v70
  v_fmac_f32 v97, v19, v70
  v_fmac_f32 v104, v18, v71
  v_fmac_f32 v105, v19, v71
  v_lshlrev_b32 v18, 16, v45
  v_and_b32 v19, 0xffff0000, v45
  v_fmac_f32 v98, v18, v70
  v_fmac_f32 v99, v19, v70
  v_fmac_f32 v106, v18, v71
  v_fmac_f32 v107, v19, v71
  v_lshlrev_b32 v18, 16, v46
  v_and_b32 v19, 0xffff0000, v46
  v_fmac_f32 v100, v18, v70
  v_fmac_f32 v101, v19, v70
  v_fmac_f32 v108, v18, v71
  v_fmac_f32 v109, v19, v71
  v_lshlrev_b32 v18, 16, v47
  v_and_b32 v19, 0xffff0000, v47
  v_fmac_f32 v102, v18, v70
  v_fmac_f32 v103, v19, v70
  v_fmac_f32 v110, v18, v71
  v_fmac_f32 v111, v19, v71
  v_lshlrev_b32 v18, 16, v48
  v_and_b32 v19, 0xffff0000, v48
  v_fmac_f32 v96, v18, v72
  v_fmac_f32 v97, v19, v72
  v_fmac_f32 v104, v18, v73
  v_fmac_f32 v105, v19, v73
  v_lshlrev_b32 v18, 16, v49
  v_and_b32 v19, 0xffff0000, v49
  v_fmac_f32 v98, v18, v72
  v_fmac_f32 v99, v19, v72
  v_fmac_f32 v106, v18, v73
  v_fmac_f32 v107, v19, v73
  v_lshlrev_b32 v18, 16, v50
  v_and_b32 v19, 0xffff0000, v50
  v_fmac_f32 v100, v18, v72
  v_fmac_f32 v101, v19, v72
  v_fmac_f32 v108, v18, v73
  v_fmac_f32 v109, v19, v73
  v_lshlrev_b32 v18, 16, v51
  v_and_b32 v19, 0xffff0000, v51
  v_fmac_f32 v102, v18, v72
  v_fmac_f32 v103, v19, v72
  v_fmac_f32 v110, v18, v73
  v_fmac_f32 v111, v19, v73
  v_lshlrev_b32 v18, 16, v52
  v_and_b32 v19, 0xffff0000, v52
  v_fmac_f32 v96, v18, v74
  v_fmac_f32 v97, v19, v74
  v_fmac_f32 v104, v18, v75
  v_fmac_f32 v105, v19, v75
  v_lshlrev_b32 v18, 16, v53
  v_and_b32 v19, 0xffff0000, v53
  v_fmac_f32 v98, v18, v74
  v_fmac_f32 v99, v19, v74
  v_fmac_f32 v106, v18, v75
  v_fmac_f32 v107, v19, v75
  v_lshlrev_b32 v18, 16, v54
  v_and_b32 v19, 0xffff0000, v54
  v_fmac_f32 v100, v18, v74
  v_fmac_f32 v101, v19, v74
  v_fmac_f32 v108, v18, v75
  v_fmac_f32 v109, v19, v75
  v_lshlrev_b32 v18, 16, v55
  v_and_b32 v19, 0xffff0000, v55
  v_fmac_f32 v102, v18, v74
  v_fmac_f32 v103, v19, v74
  v_fmac_f32 v110, v18, v75
  v_fmac_f32 v111, v19, v75
  v_lshlrev_b32 v18, 16, v56
  v_and_b32 v19, 0xffff0000, v56
  v_fmac_f32 v96, v18, v76
  v_fmac_f32 v97, v19, v76
  v_fmac_f32 v104, v18, v77
  v_fmac_f32 v105, v19, v77
  v_lshlrev_b32 v18, 16, v57
  v_and_b32 v19, 0xffff0000, v57
  v_fmac_f32 v98, v18, v76
  v_fmac_f32 v99, v19, v76
  v_fmac_f32 v106, v18, v77
  v_fmac_f32 v107, v19, v77
  v_lshlrev_b32 v18, 16, v58
  v_and_b32 v19, 0xffff0000, v58
  v_fmac_f32 v100, v18, v76
  v_fmac_f32 v101, v19, v76
  v_fmac_f32 v108, v18, v77
  v_fmac_f32 v109, v19, v77
  v_lshlrev_b32 v18, 16, v59
  v_and_b32 v19, 0xffff0000, v59
  v_fmac_f32 v102, v18, v76
  v_fmac_f32 v103, v19, v76
  v_fmac_f32 v110, v18, v77
  v_fmac_f32 v111, v19, v77
  v_lshlrev_b32 v18, 16, v60
  v_and_b32 v19, 0xffff0000, v60
  v_fmac_f32 v96, v18, v78
  v_fmac_f32 v97, v19, v78
  v_fmac_f32 v104, v18, v79
  v_fmac_f32 v105, v19, v79
  v_lshlrev_b32 v18, 16, v61
  v_and_b32 v19, 0xffff0000, v61
  v_fmac_f32 v98, v18, v78
  v_fmac_f32 v99, v19, v78
  v_fmac_f32 v106, v18, v79
  v_fmac_f32 v107, v19, v79
  v_lshlrev_b32 v18, 16, v62
  v_and_b32 v19, 0xffff0000, v62
  v_fmac_f32 v100, v18, v78
  v_fmac_f32 v101, v19, v78
  v_fmac_f32 v108, v18, v79
  v_fmac_f32 v109, v19, v79
  v_lshlrev_b32 v18, 16, v63
  v_and_b32 v19, 0xffff0000, v63
  v_fmac_f32 v102, v18, v78
  v_fmac_f32 v103, v19, v78
  v_fmac_f32 v110, v18, v79
  v_fmac_f32 v111, v19, v79
  s_nop 1
  v_add_f32_dpp v96, v96, v96 row_ror:8 row_mask:0xf bank_mask:0xf
  v_add_f32_dpp v97, v97, v97 row_ror:8 row_mask:0xf bank_mask:0xf
  v_add_f32_dpp v98, v98, v98 row_ror:8 row_mask:0xf bank_mask:0xf
  v_add_f32_dpp v99, v99, v99 row_ror:8 row_mask:0xf bank_mask:0xf
  v_add_f32_dpp v100, v100, v100 row_ror:8 row_mask:0xf bank_mask:0xf
  v_add_f32_dpp v101, v101, v101 row_ror:8 row_mask:0xf bank_mask:0xf
  v_add_f32_dpp v102, v102, v102 row_ror:8 row_mask:0xf bank_mask:0xf
  v_add_f32_dpp v103, v103, v103 row_ror:8 row_mask:0xf bank_mask:0xf
  v_add_f32_dpp v104, v104, v104 row_ror:8 row_mask:0xf bank_mask:0xf
  v_add_f32_dpp v105, v105, v105 row_ror:8 row_mask:0xf bank_mask:0xf
  v_add_f32_dpp v106, v106, v106 row_ror:8 row_mask:0xf bank_mask:0xf
  v_add_f32_dpp v107, v107, v107 row_ror:8 row_mask:0xf bank_mask:0xf
  v_add_f32_dpp v108, v108, v108 row_ror:8 row_mask:0xf bank_mask:0xf
  v_add_f32_dpp v109, v109, v109 row_ror:8 row_mask:0xf bank_mask:0xf
  v_add_f32_dpp v110, v110, v110 row_ror:8 row_mask:0xf bank_mask:0xf
  v_add_f32_dpp v111, v111, v111 row_ror:8 row_mask:0xf bank_mask:0xf
  v_lshrrev_b32 v17, 4, v0
  v_lshlrev_b32 v17, 9, v17
  v_and_b32 v18, 7, v0
  v_lshl_add_u32 v17, v18, 5, v17
  ds_write_b128 v17, v[96:99] offset:2048
  ds_write_b128 v17, v[100:103] offset:2064
  ds_write_b128 v17, v[104:107] offset:2304
  ds_write_b128 v17, v[108:111] offset:2320
  v_lshlrev_b32 v18, 2, v0
  s_waitcnt lgkmcnt(0)
  s_barrier
  v_cmp_gt_u32 vcc, 128, v0
  s_and_saveexec_b64 s[42:43], vcc
  s_cbranch_execz B_w1
  ds_read_b32 v32, v18 offset:2048
  ds_read_b32 v33, v18 offset:2560
  ds_read_b32 v34, v18 offset:3072
  ds_read_b32 v35, v18 offset:3584
  ds_read_b32 v36, v18 offset:4096
  ds_read_b32 v37, v18 offset:4608
  ds_read_b32 v38, v18 offset:5120
  ds_read_b32 v39, v18 offset:5632
  ds_read_b32 v40, v18 offset:6144
  ds_read_b32 v41, v18 offset:6656
  ds_read_b32 v42, v18 offset:7168
  ds_read_b32 v43, v18 offset:7680
  ds_read_b32 v44, v18 offset:8192
  ds_read_b32 v45, v18 offset:8704
  ds_read_b32 v46, v18 offset:9216
  ds_read_b32 v47, v18 offset:9728
  v_lshlrev_b32 v19, 11, v2
  v_lshl_add_u32 v19, v1, 2, v19
  s_lshl_b32 s39, s37, 8
  s_add_u32 s39, s39, 262144
  s_waitcnt lgkmcnt(0)
  v_add_f32 v32, v32, v33
  v_add_f32 v32, v32, v34
  v_add_f32 v32, v32, v35
  v_add_f32 v32, v32, v36
  v_add_f32 v32, v32, v37
  v_add_f32 v32, v32, v38
  v_add_f32 v32, v32, v39
  v_add_f32 v32, v32, v40
  v_add_f32 v32, v32, v41
  v_add_f32 v32, v32, v42
  v_add_f32 v32, v32, v43
  v_add_f32 v32, v32, v44
  v_add_f32 v32, v32, v45
  v_add_f32 v32, v32, v46
  v_add_f32 v32, v32, v47
  buffer_atomic_add_f32 v32, v19, s[20:23], s39 offen sc0
  s_waitcnt vmcnt(0)
B_w1:
  s_mov_b64 exec, s[42:43]
  s_branch B_arrive
B_ffn:
  s_mov_b32 s28, s12
  s_and_b32 s29, s13, 0xffff
  s_mov_b32 s30, 1409024
  s_mov_b32 s31, 0x00020000
  s_sub_u32 s36, s2, 128
  s_lshl_b32 s39, s36, 15
  s_lshl_b32 s38, s36, 7
  s_add_u32 s38, s38, 270336
  v_lshrrev_b32 v3, 5, v1
  v_and_b32 v4, 31, v1
  s_movk_i32 s40, 5632
  v_mul_lo_u32 v5, v3, s40
  v_lshl_add_u32 v5, v4, 2, v5
  v_add_u32 v8, 11264, v5
  v_readfirstlane_b32 s41, v2
  s_cmp_lg_u32 s41, 0
  s_cbranch_scc1 B_d0
  buffer_load_dword v32, v5, s[20:23], s38 offen
  buffer_load_dword v40, v8, s[20:23], s38 offen
  s_add_u32 s38, s38, 22528
  buffer_load_dword v33, v5, s[20:23], s38 offen
  buffer_load_dword v41, v8, s[20:23], s38 offen
  s_add_u32 s38, s38, 22528
  buffer_load_dword v34, v5, s[20:23], s38 offen
  buffer_load_dword v42, v8, s[20:23], s38 offen
  s_add_u32 s38, s38, 22528
  buffer_load_dword v35, v5, s[20:23], s38 offen
  buffer_load_dword v43, v8, s[20:23], s38 offen
  s_add_u32 s38, s38, 22528
  buffer_load_dword v36, v5, s[20:23], s38 offen
  buffer_load_dword v44, v8, s[20:23], s38 offen
  s_add_u32 s38, s38, 22528
  buffer_load_dword v37, v5, s[20:23], s38 offen
  buffer_load_dword v45, v8, s[20:23], s38 offen
  s_add_u32 s38, s38, 22528
  buffer_load_dword v38, v5, s[20:23], s38 offen
  buffer_load_dword v46, v8, s[20:23], s38 offen
  s_add_u32 s38, s38, 22528
  buffer_load_dword v39, v5, s[20:23], s38 offen
  buffer_load_dword v47, v8, s[20:23], s38 offen
B_d0:
  v_lshlrev_b32 v7, 13, v2
  v_lshl_add_u32 v7, v1, 4, v7
  v_add_u32 v6, 4096, v7
  buffer_load_dwordx4 v[96:99], v7, s[28:31], s39 offen offset:0 nt
  buffer_load_dwordx4 v[100:103], v7, s[28:31], s39 offen offset:1024 nt
  buffer_load_dwordx4 v[104:107], v7, s[28:31], s39 offen offset:2048 nt
  buffer_load_dwordx4 v[108:111], v7, s[28:31], s39 offen offset:3072 nt
  buffer_load_dwordx4 v[112:115], v6, s[28:31], s39 offen offset:0 nt
  buffer_load_dwordx4 v[116:119], v6, s[28:31], s39 offen offset:1024 nt
  buffer_load_dwordx4 v[120:123], v6, s[28:31], s39 offen offset:2048 nt
  buffer_load_dwordx4 v[124:127], v6, s[28:31], s39 offen offset:3072 nt
  s_cmp_lg_u32 s41, 0
  s_cbranch_scc1 B_d1
  s_waitcnt vmcnt(8)
  v_add_f32 v32, v32, v33
  v_add_f32 v40, v40, v41
  v_add_f32 v32, v32, v34
  v_add_f32 v40, v40, v42
  v_add_f32 v32, v32, v35
  v_add_f32 v40, v40, v43
  v_add_f32 v32, v32, v36
  v_add_f32 v40, v40, v44
  v_add_f32 v32, v32, v37
  v_add_f32 v40, v40, v45
  v_add_f32 v32, v32, v38
  v_add_f32 v40, v40, v46
  v_add_f32 v32, v32, v39
  v_add_f32 v40, v40, v47
  v_cvt_pk_bf16_f32 v32, v32, v32
  v_lshlrev_b32 v32, 16, v32
  v_cvt_pk_bf16_f32 v40, v40, v40
  v_lshlrev_b32 v40, 16, v40
  v_mul_f32 v34, v32, v32
  v_mul_f32 v34, v34, v32
  v_mul_f32 v34, 0x3d372713, v34
  v_add_f32 v34, v34, v32
  v_mul_f32 v34, 0x40135761, v34
  v_exp_f32 v34, v34
  s_nop 0
  v_add_f32 v34, 1.0, v34
  v_rcp_f32 v34, v34
  s_nop 0
  v_sub_f32 v34, 1.0, v34
  v_mul_f32 v34, v34, v32
  v_cvt_pk_bf16_f32 v34, v34, v34
  v_lshlrev_b32 v34, 16, v34
  v_mul_f32 v34, v34, v40
  v_cvt_pk_bf16_f32 v34, v34, v34
  v_lshlrev_b32 v34, 16, v34
  v_lshlrev_b32 v4, 3, v4
  v_lshl_add_u32 v4, v3, 2, v4
  ds_write_b32 v4, v34 offset:0
  s_waitcnt lgkmcnt(0)
B_d1:
  v_mov_b32 v128, 0
  v_mov_b32 v129, 0
  v_mov_b32 v130, 0
  v_mov_b32 v131, 0
  v_mov_b32 v132, 0
  v_mov_b32 v133, 0
  v_mov_b32 v134, 0
  v_mov_b32 v135, 0
  v_mov_b32 v136, 0
  v_mov_b32 v137, 0
  v_mov_b32 v138, 0
  v_mov_b32 v139, 0
  v_mov_b32 v140, 0
  v_mov_b32 v141, 0
  v_mov_b32 v142, 0
  v_mov_b32 v143, 0
  v_lshlrev_b32 v30, 2, v0
  v_lshlrev_b32 v27, 6, v2
  s_barrier
  ds_read_b64 v[8:9], v27 offset:0
  ds_read_b64 v[10:11], v27 offset:8
  ds_read_b64 v[12:13], v27 offset:16
  ds_read_b64 v[14:15], v27 offset:24
  ds_read_b64 v[16:17], v27 offset:32
  ds_read_b64 v[18:19], v27 offset:40
  ds_read_b64 v[20:21], v27 offset:48
  ds_read_b64 v[22:23], v27 offset:56
  s_waitcnt lgkmcnt(0)
  s_waitcnt vmcnt(7)
  v_lshlrev_b32 v28, 16, v96
  v_and_b32 v29, 0xffff0000, v96
  v_fmac_f32 v128, v28, v8
  v_fmac_f32 v129, v29, v8
  v_fmac_f32 v136, v28, v9
  v_fmac_f32 v137, v29, v9
  v_lshlrev_b32 v28, 16, v97
  v_and_b32 v29, 0xffff0000, v97
  v_fmac_f32 v130, v28, v8
  v_fmac_f32 v131, v29, v8
  v_fmac_f32 v138, v28, v9
  v_fmac_f32 v139, v29, v9
  v_lshlrev_b32 v28, 16, v98
  v_and_b32 v29, 0xffff0000, v98
  v_fmac_f32 v132, v28, v8
  v_fmac_f32 v133, v29, v8
  v_fmac_f32 v140, v28, v9
  v_fmac_f32 v141, v29, v9
  v_lshlrev_b32 v28, 16, v99
  v_and_b32 v29, 0xffff0000, v99
  v_fmac_f32 v134, v28, v8
  v_fmac_f32 v135, v29, v8
  v_fmac_f32 v142, v28, v9
  v_fmac_f32 v143, v29, v9
  s_waitcnt vmcnt(6)
  v_lshlrev_b32 v28, 16, v100
  v_and_b32 v29, 0xffff0000, v100
  v_fmac_f32 v128, v28, v10
  v_fmac_f32 v129, v29, v10
  v_fmac_f32 v136, v28, v11
  v_fmac_f32 v137, v29, v11
  v_lshlrev_b32 v28, 16, v101
  v_and_b32 v29, 0xffff0000, v101
  v_fmac_f32 v130, v28, v10
  v_fmac_f32 v131, v29, v10
  v_fmac_f32 v138, v28, v11
  v_fmac_f32 v139, v29, v11
  v_lshlrev_b32 v28, 16, v102
  v_and_b32 v29, 0xffff0000, v102
  v_fmac_f32 v132, v28, v10
  v_fmac_f32 v133, v29, v10
  v_fmac_f32 v140, v28, v11
  v_fmac_f32 v141, v29, v11
  v_lshlrev_b32 v28, 16, v103
  v_and_b32 v29, 0xffff0000, v103
  v_fmac_f32 v134, v28, v10
  v_fmac_f32 v135, v29, v10
  v_fmac_f32 v142, v28, v11
  v_fmac_f32 v143, v29, v11
  s_waitcnt vmcnt(5)
  v_lshlrev_b32 v28, 16, v104
  v_and_b32 v29, 0xffff0000, v104
  v_fmac_f32 v128, v28, v12
  v_fmac_f32 v129, v29, v12
  v_fmac_f32 v136, v28, v13
  v_fmac_f32 v137, v29, v13
  v_lshlrev_b32 v28, 16, v105
  v_and_b32 v29, 0xffff0000, v105
  v_fmac_f32 v130, v28, v12
  v_fmac_f32 v131, v29, v12
  v_fmac_f32 v138, v28, v13
  v_fmac_f32 v139, v29, v13
  v_lshlrev_b32 v28, 16, v106
  v_and_b32 v29, 0xffff0000, v106
  v_fmac_f32 v132, v28, v12
  v_fmac_f32 v133, v29, v12
  v_fmac_f32 v140, v28, v13
  v_fmac_f32 v141, v29, v13
  v_lshlrev_b32 v28, 16, v107
  v_and_b32 v29, 0xffff0000, v107
  v_fmac_f32 v134, v28, v12
  v_fmac_f32 v135, v29, v12
  v_fmac_f32 v142, v28, v13
  v_fmac_f32 v143, v29, v13
  s_waitcnt vmcnt(4)
  v_lshlrev_b32 v28, 16, v108
  v_and_b32 v29, 0xffff0000, v108
  v_fmac_f32 v128, v28, v14
  v_fmac_f32 v129, v29, v14
  v_fmac_f32 v136, v28, v15
  v_fmac_f32 v137, v29, v15
  v_lshlrev_b32 v28, 16, v109
  v_and_b32 v29, 0xffff0000, v109
  v_fmac_f32 v130, v28, v14
  v_fmac_f32 v131, v29, v14
  v_fmac_f32 v138, v28, v15
  v_fmac_f32 v139, v29, v15
  v_lshlrev_b32 v28, 16, v110
  v_and_b32 v29, 0xffff0000, v110
  v_fmac_f32 v132, v28, v14
  v_fmac_f32 v133, v29, v14
  v_fmac_f32 v140, v28, v15
  v_fmac_f32 v141, v29, v15
  v_lshlrev_b32 v28, 16, v111
  v_and_b32 v29, 0xffff0000, v111
  v_fmac_f32 v134, v28, v14
  v_fmac_f32 v135, v29, v14
  v_fmac_f32 v142, v28, v15
  v_fmac_f32 v143, v29, v15
  s_waitcnt vmcnt(3)
  v_lshlrev_b32 v28, 16, v112
  v_and_b32 v29, 0xffff0000, v112
  v_fmac_f32 v128, v28, v16
  v_fmac_f32 v129, v29, v16
  v_fmac_f32 v136, v28, v17
  v_fmac_f32 v137, v29, v17
  v_lshlrev_b32 v28, 16, v113
  v_and_b32 v29, 0xffff0000, v113
  v_fmac_f32 v130, v28, v16
  v_fmac_f32 v131, v29, v16
  v_fmac_f32 v138, v28, v17
  v_fmac_f32 v139, v29, v17
  v_lshlrev_b32 v28, 16, v114
  v_and_b32 v29, 0xffff0000, v114
  v_fmac_f32 v132, v28, v16
  v_fmac_f32 v133, v29, v16
  v_fmac_f32 v140, v28, v17
  v_fmac_f32 v141, v29, v17
  v_lshlrev_b32 v28, 16, v115
  v_and_b32 v29, 0xffff0000, v115
  v_fmac_f32 v134, v28, v16
  v_fmac_f32 v135, v29, v16
  v_fmac_f32 v142, v28, v17
  v_fmac_f32 v143, v29, v17
  s_waitcnt vmcnt(2)
  v_lshlrev_b32 v28, 16, v116
  v_and_b32 v29, 0xffff0000, v116
  v_fmac_f32 v128, v28, v18
  v_fmac_f32 v129, v29, v18
  v_fmac_f32 v136, v28, v19
  v_fmac_f32 v137, v29, v19
  v_lshlrev_b32 v28, 16, v117
  v_and_b32 v29, 0xffff0000, v117
  v_fmac_f32 v130, v28, v18
  v_fmac_f32 v131, v29, v18
  v_fmac_f32 v138, v28, v19
  v_fmac_f32 v139, v29, v19
  v_lshlrev_b32 v28, 16, v118
  v_and_b32 v29, 0xffff0000, v118
  v_fmac_f32 v132, v28, v18
  v_fmac_f32 v133, v29, v18
  v_fmac_f32 v140, v28, v19
  v_fmac_f32 v141, v29, v19
  v_lshlrev_b32 v28, 16, v119
  v_and_b32 v29, 0xffff0000, v119
  v_fmac_f32 v134, v28, v18
  v_fmac_f32 v135, v29, v18
  v_fmac_f32 v142, v28, v19
  v_fmac_f32 v143, v29, v19
  s_waitcnt vmcnt(1)
  v_lshlrev_b32 v28, 16, v120
  v_and_b32 v29, 0xffff0000, v120
  v_fmac_f32 v128, v28, v20
  v_fmac_f32 v129, v29, v20
  v_fmac_f32 v136, v28, v21
  v_fmac_f32 v137, v29, v21
  v_lshlrev_b32 v28, 16, v121
  v_and_b32 v29, 0xffff0000, v121
  v_fmac_f32 v130, v28, v20
  v_fmac_f32 v131, v29, v20
  v_fmac_f32 v138, v28, v21
  v_fmac_f32 v139, v29, v21
  v_lshlrev_b32 v28, 16, v122
  v_and_b32 v29, 0xffff0000, v122
  v_fmac_f32 v132, v28, v20
  v_fmac_f32 v133, v29, v20
  v_fmac_f32 v140, v28, v21
  v_fmac_f32 v141, v29, v21
  v_lshlrev_b32 v28, 16, v123
  v_and_b32 v29, 0xffff0000, v123
  v_fmac_f32 v134, v28, v20
  v_fmac_f32 v135, v29, v20
  v_fmac_f32 v142, v28, v21
  v_fmac_f32 v143, v29, v21
  s_waitcnt vmcnt(0)
  v_lshlrev_b32 v28, 16, v124
  v_and_b32 v29, 0xffff0000, v124
  v_fmac_f32 v128, v28, v22
  v_fmac_f32 v129, v29, v22
  v_fmac_f32 v136, v28, v23
  v_fmac_f32 v137, v29, v23
  v_lshlrev_b32 v28, 16, v125
  v_and_b32 v29, 0xffff0000, v125
  v_fmac_f32 v130, v28, v22
  v_fmac_f32 v131, v29, v22
  v_fmac_f32 v138, v28, v23
  v_fmac_f32 v139, v29, v23
  v_lshlrev_b32 v28, 16, v126
  v_and_b32 v29, 0xffff0000, v126
  v_fmac_f32 v132, v28, v22
  v_fmac_f32 v133, v29, v22
  v_fmac_f32 v140, v28, v23
  v_fmac_f32 v141, v29, v23
  v_lshlrev_b32 v28, 16, v127
  v_and_b32 v29, 0xffff0000, v127
  v_fmac_f32 v134, v28, v22
  v_fmac_f32 v135, v29, v22
  v_fmac_f32 v142, v28, v23
  v_fmac_f32 v143, v29, v23
  v_lshlrev_b32 v28, 12, v2
  v_lshl_add_u32 v28, v1, 5, v28
  ds_write_b128 v28, v[128:131] offset:16384
  ds_write_b128 v28, v[132:135] offset:16400
  ds_write_b128 v28, v[136:139] offset:18432
  ds_write_b128 v28, v[140:143] offset:18448
  s_waitcnt lgkmcnt(0)
  s_barrier
  ds_read_b32 v32, v30 offset:16384
  ds_read_b32 v33, v30 offset:20480
  ds_read_b32 v34, v30 offset:24576
  ds_read_b32 v35, v30 offset:28672
  ds_read_b32 v36, v30 offset:17408
  ds_read_b32 v37, v30 offset:21504
  ds_read_b32 v38, v30 offset:25600
  ds_read_b32 v39, v30 offset:29696
  ds_read_b32 v40, v30 offset:18432
  ds_read_b32 v41, v30 offset:22528
  ds_read_b32 v42, v30 offset:26624
  ds_read_b32 v43, v30 offset:30720
  ds_read_b32 v44, v30 offset:19456
  ds_read_b32 v45, v30 offset:23552
  ds_read_b32 v46, v30 offset:27648
  ds_read_b32 v47, v30 offset:31744
  s_mov_b32 s39, 266240
  s_waitcnt lgkmcnt(0)
  v_add_f32 v32, v32, v33
  v_add_f32 v34, v34, v35
  v_add_f32 v32, v32, v34
  buffer_atomic_add_f32 v32, v30, s[20:23], s39 offen offset:0 sc0
  v_add_f32 v36, v36, v37
  v_add_f32 v38, v38, v39
  v_add_f32 v36, v36, v38
  buffer_atomic_add_f32 v36, v30, s[20:23], s39 offen offset:1024 sc0
  v_add_f32 v40, v40, v41
  v_add_f32 v42, v42, v43
  v_add_f32 v40, v40, v42
  buffer_atomic_add_f32 v40, v30, s[20:23], s39 offen offset:2048 sc0
  v_add_f32 v44, v44, v45
  v_add_f32 v46, v46, v47
  v_add_f32 v44, v44, v46
  buffer_atomic_add_f32 v44, v30, s[20:23], s39 offen offset:3072 sc0
  s_waitcnt vmcnt(0)
B_arrive:
  s_barrier
  v_cmp_eq_u32 vcc, 0, v0
  s_and_saveexec_b64 s[42:43], vcc
  s_cbranch_execz B_a1
  s_waitcnt lgkmcnt(0)
  s_mov_b32 s24, s50
  s_and_b32 s25, s51, 0xffff
  s_mov_b32 s26, 256
  s_mov_b32 s27, 0x00020000
  v_mov_b32 v3, 0
  v_mov_b32 v4, 1
  buffer_atomic_add v4, v3, s[24:27], 0 offen sc0
  s_waitcnt vmcnt(0)
  ds_write_b32 v3, v4 offset:36864
  s_waitcnt lgkmcnt(0)
B_a1:
  s_mov_b64 exec, s[42:43]
  v_mov_b32 v3, 0
  s_barrier
  ds_read_b32 v4, v3 offset:36864
  s_waitcnt lgkmcnt(0)
  v_readfirstlane_b32 s44, v4
  s_cmp_lg_u32 s44, 170
  s_cbranch_scc1 B_end
  s_mov_b32 s12, s4
  s_and_b32 s13, s5, 0xffff
  s_mov_b32 s14, 2048
  s_mov_b32 s15, 0x00020000
  s_mov_b32 s16, s48
  s_and_b32 s17, s49, 0xffff
  s_mov_b32 s18, 2048
  s_mov_b32 s19, 0x00020000
  v_lshlrev_b32 v30, 2, v0
  v_lshlrev_b32 v31, 1, v0
  s_mov_b32 s38, 262144
  s_mov_b32 s39, 266240
  v_mov_b32 v32, 0
  v_mov_b32 v36, 0
  v_mov_b32 v33, 0
  v_mov_b32 v37, 0
  v_mov_b32 v34, 0
  v_mov_b32 v38, 0
  v_mov_b32 v35, 0
  v_mov_b32 v39, 0
  buffer_atomic_add_f32 v32, v30, s[20:23], s38 offen offset:0 sc0
  buffer_atomic_add_f32 v36, v30, s[20:23], s39 offen offset:0 sc0
  buffer_load_ushort v40, v31, s[12:15], 0 offen offset:0
  buffer_atomic_add_f32 v33, v30, s[20:23], s38 offen offset:1024 sc0
  buffer_atomic_add_f32 v37, v30, s[20:23], s39 offen offset:1024 sc0
  buffer_load_ushort v41, v31, s[12:15], 0 offen offset:512
  buffer_atomic_add_f32 v34, v30, s[20:23], s38 offen offset:2048 sc0
  buffer_atomic_add_f32 v38, v30, s[20:23], s39 offen offset:2048 sc0
  buffer_load_ushort v42, v31, s[12:15], 0 offen offset:1024
  buffer_atomic_add_f32 v35, v30, s[20:23], s38 offen offset:3072 sc0
  buffer_atomic_add_f32 v39, v30, s[20:23], s39 offen offset:3072 sc0
  buffer_load_ushort v43, v31, s[12:15], 0 offen offset:1536
  s_waitcnt vmcnt(0)
  v_cvt_pk_bf16_f32 v32, v32, v32
  v_lshlrev_b32 v32, 16, v32
  v_cvt_pk_bf16_f32 v36, v36, v36
  v_lshlrev_b32 v36, 16, v36
  v_mul_f32 v44, 0xbfb8aa3b, v36
  v_exp_f32 v44, v44
  s_nop 0
  v_add_f32 v44, 1.0, v44
  v_rcp_f32 v44, v44
  s_nop 0
  v_mul_f32 v44, v44, v36
  v_cvt_pk_bf16_f32 v44, v44, v44
  v_lshlrev_b32 v44, 16, v44
  v_mul_f32 v44, v44, v32
  v_cvt_pk_bf16_f32 v44, v44, v44
  v_lshlrev_b32 v44, 16, v44
  v_lshlrev_b32 v40, 16, v40
  v_add_f32 v44, v44, v40
  v_cvt_pk_bf16_f32 v40, v44, v44
  buffer_store_short v40, v31, s[16:19], 0 offen offset:0
  v_cvt_pk_bf16_f32 v33, v33, v33
  v_lshlrev_b32 v33, 16, v33
  v_cvt_pk_bf16_f32 v37, v37, v37
  v_lshlrev_b32 v37, 16, v37
  v_mul_f32 v44, 0xbfb8aa3b, v37
  v_exp_f32 v44, v44
  s_nop 0
  v_add_f32 v44, 1.0, v44
  v_rcp_f32 v44, v44
  s_nop 0
  v_mul_f32 v44, v44, v37
  v_cvt_pk_bf16_f32 v44, v44, v44
  v_lshlrev_b32 v44, 16, v44
  v_mul_f32 v44, v44, v33
  v_cvt_pk_bf16_f32 v44, v44, v44
  v_lshlrev_b32 v44, 16, v44
  v_lshlrev_b32 v41, 16, v41
  v_add_f32 v44, v44, v41
  v_cvt_pk_bf16_f32 v41, v44, v44
  buffer_store_short v41, v31, s[16:19], 0 offen offset:512
  v_cvt_pk_bf16_f32 v34, v34, v34
  v_lshlrev_b32 v34, 16, v34
  v_cvt_pk_bf16_f32 v38, v38, v38
  v_lshlrev_b32 v38, 16, v38
  v_mul_f32 v44, 0xbfb8aa3b, v38
  v_exp_f32 v44, v44
  s_nop 0
  v_add_f32 v44, 1.0, v44
  v_rcp_f32 v44, v44
  s_nop 0
  v_mul_f32 v44, v44, v38
  v_cvt_pk_bf16_f32 v44, v44, v44
  v_lshlrev_b32 v44, 16, v44
  v_mul_f32 v44, v44, v34
  v_cvt_pk_bf16_f32 v44, v44, v44
  v_lshlrev_b32 v44, 16, v44
  v_lshlrev_b32 v42, 16, v42
  v_add_f32 v44, v44, v42
  v_cvt_pk_bf16_f32 v42, v44, v44
  buffer_store_short v42, v31, s[16:19], 0 offen offset:1024
  v_cvt_pk_bf16_f32 v35, v35, v35
  v_lshlrev_b32 v35, 16, v35
  v_cvt_pk_bf16_f32 v39, v39, v39
  v_lshlrev_b32 v39, 16, v39
  v_mul_f32 v44, 0xbfb8aa3b, v39
  v_exp_f32 v44, v44
  s_nop 0
  v_add_f32 v44, 1.0, v44
  v_rcp_f32 v44, v44
  s_nop 0
  v_mul_f32 v44, v44, v39
  v_cvt_pk_bf16_f32 v44, v44, v44
  v_lshlrev_b32 v44, 16, v44
  v_mul_f32 v44, v44, v35
  v_cvt_pk_bf16_f32 v44, v44, v44
  v_lshlrev_b32 v44, 16, v44
  v_lshlrev_b32 v43, 16, v43
  v_add_f32 v44, v44, v43
  v_cvt_pk_bf16_f32 v43, v44, v44
  buffer_store_short v43, v31, s[16:19], 0 offen offset:1536
B_end:
  s_endpgm
.section .rodata,"a"
.p2align 6
.amdhsa_kernel attn_kernel
  .amdhsa_next_free_vgpr 128
  .amdhsa_next_free_sgpr 100
  .amdhsa_accum_offset 128
  .amdhsa_group_segment_fixed_size 0
  .amdhsa_kernarg_size 96
  .amdhsa_user_sgpr_count 2
  .amdhsa_user_sgpr_kernarg_segment_ptr 1
  .amdhsa_system_sgpr_workgroup_id_x 1
.end_amdhsa_kernel
.p2align 6
.amdhsa_kernel proj_kernel
  .amdhsa_next_free_vgpr 168
  .amdhsa_next_free_sgpr 64
  .amdhsa_accum_offset 168
  .amdhsa_group_segment_fixed_size 0
  .amdhsa_kernarg_size 96
  .amdhsa_user_sgpr_count 2
  .amdhsa_user_sgpr_kernarg_segment_ptr 1
  .amdhsa_system_sgpr_workgroup_id_x 1
.end_amdhsa_kernel
```
